```python
import torch

def _softmax(x, axis=-1):
    return torch.softmax(x, dim=axis)
def _gelu(x):
    return torch.nn.functional.gelu(x, approximate="tanh")
def _silu(x):
    return torch.nn.functional.silu(x)
def _sigmoid(x):
    return torch.sigmoid(x)
def _layernorm(x, axis=-1, eps=1e-5):
    m = x.mean(dim=axis, keepdim=True)
    v = x.var(dim=axis, keepdim=True, unbiased=False)
    return (x - m) / torch.sqrt(v + eps)
def _scatter_add(tgt, idx, src, axis=0):
    return tgt.clone().index_add_(axis, idx, src)
def _segment_sum(src, seg, n):
    out = torch.zeros((n,) + src.shape[1:], dtype=src.dtype)
    return out.index_add_(0, seg, src)
def _pad(x, pw):
    flat = tuple(v for pair in reversed(pw) for v in pair)
    return torch.nn.functional.pad(x, flat)

kernel_name = 'gated_mix__ssm_conv_s4__glu_gated_geglu__prompt'

def setup_inputs():

    _w = (lambda a: (lambda t: t.to(torch.bfloat16) if t.is_floating_point() else t)(torch.as_tensor(a)))
    def _A_setup():
        B, L, D, N = 1, 2048, 448, 256
        A_re = -(lambda _x: torch.exp(torch.as_tensor(_x)))((lambda *s: torch.randn(*s, dtype=torch.bfloat16) * 6.4)(D, N))
        A_im = torch.pi * (lambda *s: torch.randn(*s, dtype=torch.bfloat16) * 0.05)(D, N)
        B_re = (lambda *s: torch.randn(*s, dtype=torch.bfloat16) * 0.05)(D, N)
        B_im = (lambda *s: torch.randn(*s, dtype=torch.bfloat16) * 0.05)(D, N)
        C_re = (lambda *s: torch.randn(*s, dtype=torch.bfloat16) * 0.05)(D, N)
        C_im = (lambda *s: torch.randn(*s, dtype=torch.bfloat16) * 0.05)(D, N)
        log_dt = (lambda *s: torch.randn(*s, dtype=torch.bfloat16) * 0.05)(D) * 0.5 - 4.0
        Dskip = (lambda *s: torch.randn(*s, dtype=torch.bfloat16) * 0.05)(D)
        return {
            "u": _w((lambda *s: torch.randn(*s, dtype=torch.bfloat16) * 0.05)(B, L, D)),
            "A_re": _w(A_re),
            "A_im": _w(A_im),
            "B_re": _w(B_re),
            "B_im": _w(B_im),
            "C_re": _w(C_re),
            "C_im": _w(C_im),
            "log_dt": _w(log_dt),
            "Dskip": _w(Dskip),
        }
    _A_in = _A_setup()

    def _B_setup():
        B, S, Dm, Df = 1, 2048, 448, 1792
        return {
            "x": _w((lambda *s: torch.randn(*s, dtype=torch.bfloat16) * 0.05)(B, S, Dm)),
            "w_gate": _w((lambda *s: torch.randn(*s, dtype=torch.bfloat16) * 1.6)(Dm, Df) * (Dm ** -0.5)),
            "w_up": _w((lambda *s: torch.randn(*s, dtype=torch.bfloat16) * 1.6)(Dm, Df) * (Dm ** -0.5)),
            "w_down": _w((lambda *s: torch.randn(*s, dtype=torch.bfloat16) * 1.6)(Df, Dm) * (Df ** -0.5)),
        }
    _B_in = _B_setup()

    return {
        "A_u": _A_in["u"],
        "A_A_re": _A_in["A_re"],
        "A_A_im": _A_in["A_im"],
        "A_B_re": _A_in["B_re"],
        "A_B_im": _A_in["B_im"],
        "A_C_re": _A_in["C_re"],
        "A_C_im": _A_in["C_im"],
        "A_log_dt": _A_in["log_dt"],
        "A_Dskip": _A_in["Dskip"],
        "B_x": _B_in["x"],
        "B_w_gate": _B_in["w_gate"],
        "B_w_up": _B_in["w_up"],
        "B_w_down": _B_in["w_down"],
        "gate_w": _w((lambda *s: torch.randn(*s, dtype=torch.bfloat16) * 0.05)(448) * 16.0),
    }

def reference(A_u, A_A_re, A_A_im, A_B_re, A_B_im, A_C_re, A_C_im, A_log_dt, A_Dskip, B_x, B_w_gate, B_w_up, B_w_down, gate_w):
    def _A_ref(u, A_re, A_im, B_re, B_im, C_re, C_im, log_dt, Dskip):
        Bsz, L, D = u.shape
        dt = torch.exp(log_dt)[:, None]
        A = A_re + 1j * A_im
        Bc = B_re + 1j * B_im
        Cc = C_re + 1j * C_im
        logdA = dt * A
        dB = dt * Bc
        l = (lambda x, dt: x.to(dt))(torch.arange(L), A_re.dtype)
        P = torch.exp(logdA[:, :, None] * l[None, None, :])
        K = torch.einsum("dn,dnl,dn->dl", Cc, P, dB).real
        L2 = 2 * L
        Kp = _pad(K, ((0, 0), (0, L)))
        up = (lambda x, *d: x.permute(*d))(u, 0, 2, 1)
        up = _pad(up, ((0, 0), (0, 0), (0, L)))
        Kf = (lambda x, axes=(-2,-1): torch.fft.rfft2(x.float(), dim=axes))(Kp[:, None, :], axes=(-2, -1))
        Uf = (lambda x, axes=(-2,-1): torch.fft.rfft2(x.float(), dim=axes))(up[:, :, None, :], axes=(-2, -1))
        Yf = Uf * Kf[None, :, :, :]
        y = (lambda x, s, axes=(-2,-1): torch.fft.irfft2(x, s=s, dim=axes).to(torch.bfloat16))(Yf, (1, L2), axes=(-2, -1))[:, :, 0, :L]
        y = (lambda x, *d: x.permute(*d))(y, 0, 2, 1) + u * Dskip[None, None, :]
        return y

    def _B_ref(x, w_gate, w_up, w_down):
        g = torch.einsum("bsd,df->bsf", x, w_gate)
        u = torch.einsum("bsd,df->bsf", x, w_up)
        h = _gelu(g) * u
        return torch.einsum("bsf,fd->bsd", h, w_down)

    x = A_u
    g = _sigmoid((x * gate_w).sum(-1, keepdims=True))
    a = _A_ref(x, A_A_re, A_A_im, A_B_re, A_B_im, A_C_re, A_C_im, A_log_dt, A_Dskip)
    b = _B_ref(x, B_w_gate, B_w_up, B_w_down)
    return g * a + (1 - g) * b
```

```asm
; @launch grid=(480,1,1) block=(256,1,1) lds=81920
.amdgcn_target "amdgcn-amd-amdhsa--gfx950"
.text
.globl gated_mix__ssm_conv_s4__glu_gated_geglu__prompt_kernel
.p2align 8
.type gated_mix__ssm_conv_s4__glu_gated_geglu__prompt_kernel,@function
gated_mix__ssm_conv_s4__glu_gated_geglu__prompt_kernel:
    s_load_dwordx16 s[36:51], s[0:1], 0
    s_load_dwordx16 s[52:67], s[0:1], 64
    s_load_dwordx2 s[68:69], s[0:1], 128
    s_cmp_ge_u32 s2, 480
    s_cbranch_scc1 L_end
    s_sub_u32 s3, s2, 224
    s_cmp_ge_u32 s3, 32
    s_cbranch_scc1 L_nopf
L_pentry:
    v_readfirstlane_b32 s4, v0
    s_lshl_b32 s3, s3, 8
    s_add_u32 s3, s3, s4
    s_cmp_eq_u32 s3, 192
    s_cbranch_scc1 L_nonce
    s_getpc_b64 s[32:33]
L_pc:
    s_mov_b32 s34, L_end-L_pc
    s_mov_b32 s35, 0x20000
    v_lshlrev_b32 v1, 7, v0
    buffer_load_dword v127, v1, s[32:35], 0 offen
L_nopf:
    v_lshrrev_b32 v1, 6, v0
    s_nop 0
    v_readfirstlane_b32 s70, v1
    v_and_b32 v0, 63, v0
    s_mov_b32 s101, s2
    s_cmp_ge_u32 s2, 224
    s_cbranch_scc1 L_SP
    s_setprio 1
    s_and_b32 s77, s101, 3
    s_mul_i32 s77, s77, 28
    s_lshr_b32 s78, s101, 3
    s_add_u32 s78, s78, s77
    s_lshr_b32 s72, s78, 3
    s_and_b32 s85, s78, 7
    s_and_b32 s71, s101, 4
    s_lshl_b32 s71, s71, 1
    s_add_u32 s71, s71, s85
    s_cmp_eq_u32 s85, 7
    s_cselect_b32 s85, 3, s85
    s_lshl_b32 s77, s71, 2
    s_add_u32 s77, s77, s70
    s_mul_i32 s83, s77, 28672
    s_and_b32 s77, s70, 1
    s_mul_i32 s84, s77, 57344
    s_lshl_b32 s77, s72, 8
    s_add_u32 s84, s84, s77
    s_lshl_b32 s75, s70, 12
    s_lshl_b32 s77, s85, 7
    s_add_u32 s79, s83, s77
    s_mul_i32 s77, s85, 229376
    s_add_u32 s81, s84, s77
    v_lshrrev_b32 v12, 3, v0
    v_mul_u32_u24 v12, 896, v12
    v_and_b32 v13, 7, v0
    v_lshrrev_b32 v14, 4, v0
    v_xor_b32 v13, v13, v14
    v_lshl_add_u32 v2, v13, 4, v12
    v_xor_b32 v12, 64, v2
    v_add_u32 v3, 6144, v12
    v_add_u32 v92, 12288, v2
    v_add_u32 v93, 18432, v12
    v_mul_u32_u24 v12, 3584, v14
    v_and_b32 v13, 15, v0
    v_lshlrev_b32 v5, 2, v14
    v_xor_b32 v13, v13, v5
    v_lshl_add_u32 v4, v13, 4, v12
    v_xor_b32 v12, 32, v4
    v_add_u32 v94, 13312, v4
    v_add_u32 v95, 26624, v12
    v_add_u32 v96, 39936, v12
    s_cmp_ge_u32 s70, 2
    s_mov_b32 s6, 1835008
    s_mov_b32 s7, 0x20000
    s_mov_b32 s10, 1605632
    s_mov_b32 s11, 0x20000
    s_waitcnt lgkmcnt(0)
    s_cselect_b32 s8, s58, s56
    s_cselect_b32 s9, s59, s57
    s_mov_b32 s4, s36
    s_mov_b32 s5, s37
    s_add_u32 m0, s75, 0
    s_nop 0
    buffer_load_dwordx4 v4, s[8:11], s81 offen offset:0 lds
    buffer_load_dwordx4 v94, s[8:11], s81 offen offset:1024 lds
    buffer_load_dwordx4 v95, s[8:11], s81 offen offset:2048 lds
    buffer_load_dwordx4 v96, s[8:11], s81 offen offset:3072 lds
    s_add_u32 m0, s75, 49152
    s_nop 0
    buffer_load_dwordx4 v2, s[4:7], s79 offen offset:0 lds
    buffer_load_dwordx4 v3, s[4:7], s79 offen offset:1024 lds
    buffer_load_dwordx4 v92, s[4:7], s79 offen offset:2048 lds
    buffer_load_dwordx4 v93, s[4:7], s79 offen offset:3072 lds
    s_add_u32 m0, s75, 16384
    s_add_u32 s81, s81, 114688
    buffer_load_dwordx4 v4, s[8:11], s81 offen offset:0 lds
    buffer_load_dwordx4 v94, s[8:11], s81 offen offset:1024 lds
    buffer_load_dwordx4 v95, s[8:11], s81 offen offset:2048 lds
    buffer_load_dwordx4 v96, s[8:11], s81 offen offset:3072 lds
    s_mov_b32 s32, s64
    s_mov_b32 s33, s65
    s_mov_b32 s34, 1835008
    s_mov_b32 s35, 0x20000
    s_add_u32 s85, s85, 1
    s_cmp_eq_u32 s85, 7
    s_cselect_b32 s85, 0, s85
    s_lshl_b32 s77, s85, 7
    s_add_u32 s80, s83, s77
    s_mul_i32 s77, s85, 229376
    s_add_u32 s82, s84, s77
    s_add_u32 s85, s85, 1
    s_cmp_eq_u32 s85, 7
    s_cselect_b32 s85, 0, s85
    s_lshl_b32 s77, s85, 7
    s_add_u32 s36, s83, s77
    s_mul_i32 s77, s85, 229376
    s_add_u32 s62, s84, s77
    s_add_u32 s85, s85, 1
    s_cmp_eq_u32 s85, 7
    s_cselect_b32 s85, 0, s85
    s_lshl_b32 s77, s85, 7
    s_add_u32 s37, s83, s77
    s_mul_i32 s77, s85, 229376
    s_add_u32 s63, s84, s77
    s_add_u32 s85, s85, 1
    s_cmp_eq_u32 s85, 7
    s_cselect_b32 s85, 0, s85
    s_lshl_b32 s77, s85, 7
    s_add_u32 s51, s83, s77
    s_mul_i32 s77, s85, 229376
    s_add_u32 s64, s84, s77
    s_add_u32 s85, s85, 1
    s_cmp_eq_u32 s85, 7
    s_cselect_b32 s85, 0, s85
    s_lshl_b32 s77, s85, 7
    s_add_u32 s73, s83, s77
    s_mul_i32 s77, s85, 229376
    s_add_u32 s65, s84, s77
    s_add_u32 s85, s85, 1
    s_cmp_eq_u32 s85, 7
    s_cselect_b32 s85, 0, s85
    s_lshl_b32 s77, s85, 7
    s_add_u32 s74, s83, s77
    s_mul_i32 s77, s85, 229376
    s_add_u32 s76, s84, s77
    s_and_b32 s77, s70, 1
    s_lshl_b32 s77, s77, 13
    s_add_u32 s77, s77, 49152
    v_and_b32 v12, 15, v0
    v_lshrrev_b32 v13, 1, v12
    v_lshrrev_b32 v14, 4, v0
    v_xor_b32 v13, v13, v14
    v_lshlrev_b32 v13, 4, v13
    v_lshl_add_u32 v13, v12, 7, v13
    v_add_u32 v6, s77, v13
    v_xor_b32 v7, 64, v6
    s_and_b32 s77, s70, 2
    s_lshl_b32 s77, s77, 2
    v_lshrrev_b32 v12, 2, v0
    v_and_b32 v12, 3, v12
    v_lshl_add_u32 v13, v14, 3, v12
    v_lshlrev_b32 v13, 8, v13
    v_and_b32 v14, 1, v14
    v_lshlrev_b32 v14, 1, v14
    v_lshl_add_u32 v14, v12, 2, v14
    v_bfe_u32 v12, v0, 1, 1
    v_add_u32 v12, s77, v12
    v_xor_b32 v12, v12, v14
    v_lshl_add_u32 v13, v12, 4, v13
    v_and_b32 v12, 1, v0
    v_lshl_add_u32 v8, v12, 3, v13
    v_xor_b32 v9, 32, v8
    v_xor_b32 v10, 64, v8
    v_xor_b32 v11, 96, v8
    s_add_u32 s12, s68, 0
    s_addc_u32 s13, s69, 0
    s_mov_b32 s14, 7340032
    s_mov_b32 s15, 0x20000
    s_add_u32 s96, s68, 0
    s_addc_u32 s97, s69, 0
    s_mov_b32 s98, 7340032
    s_mov_b32 s99, 0x20000
    s_mov_b32 s16, s60
    s_mov_b32 s17, s61
    s_mov_b32 s18, 1605632
    s_mov_b32 s19, 0x20000
    s_add_u32 s20, s68, 9175040
    s_addc_u32 s21, s69, 0
    s_mov_b32 s22, 1835008
    s_mov_b32 s23, 0x20000
    s_add_u32 s24, s68, 11010048
    s_addc_u32 s25, s69, 0
    s_mov_b32 s26, 16384
    s_mov_b32 s27, 0x20000
    s_add_u32 s88, s68, 11026432
    s_addc_u32 s89, s69, 0
    s_mov_b32 s90, 294912
    s_mov_b32 s91, 0x20000
    s_mov_b32 s92, s66
    s_mov_b32 s93, s67
    s_mov_b32 s94, 256
    s_mov_b32 s95, 0x20000
    s_and_b32 s77, s101, 7
    s_lshr_b32 s78, s101, 3
    s_lshl_b32 s83, s77, 2
    s_and_b32 s77, s78, 3
    s_add_u32 s83, s83, s77
    s_lshr_b32 s84, s78, 2
    s_mul_i32 s85, s83, 224
    s_mul_i32 s77, s70, 7
    s_add_u32 s85, s85, s77
    s_lshl_b32 s85, s85, 10
    s_mul_i32 s86, s70, 401408
    s_lshl_b32 s77, s84, 7
    s_add_u32 s86, s86, s77
    s_lshl_b32 s3, s70, 12
    s_mov_b32 s77, s84
    s_lshl_b32 s78, s77, 10
    s_add_u32 s44, s85, s78
    s_mul_i32 s78, s77, 57344
    s_add_u32 s52, s86, s78
    s_add_u32 s77, s77, 1
    s_cmp_eq_u32 s77, 7
    s_cselect_b32 s77, 0, s77
    s_lshl_b32 s78, s77, 10
    s_add_u32 s45, s85, s78
    s_mul_i32 s78, s77, 57344
    s_add_u32 s53, s86, s78
    s_add_u32 s77, s77, 1
    s_cmp_eq_u32 s77, 7
    s_cselect_b32 s77, 0, s77
    s_lshl_b32 s78, s77, 10
    s_add_u32 s46, s85, s78
    s_mul_i32 s78, s77, 57344
    s_add_u32 s54, s86, s78
    s_add_u32 s77, s77, 1
    s_cmp_eq_u32 s77, 7
    s_cselect_b32 s77, 0, s77
    s_lshl_b32 s78, s77, 10
    s_add_u32 s47, s85, s78
    s_mul_i32 s78, s77, 57344
    s_add_u32 s55, s86, s78
    s_add_u32 s77, s77, 1
    s_cmp_eq_u32 s77, 7
    s_cselect_b32 s77, 0, s77
    s_lshl_b32 s78, s77, 10
    s_add_u32 s48, s85, s78
    s_mul_i32 s78, s77, 57344
    s_add_u32 s56, s86, s78
    s_add_u32 s77, s77, 1
    s_cmp_eq_u32 s77, 7
    s_cselect_b32 s77, 0, s77
    s_lshl_b32 s78, s77, 10
    s_add_u32 s49, s85, s78
    s_mul_i32 s78, s77, 57344
    s_add_u32 s57, s86, s78
    s_add_u32 s77, s77, 1
    s_cmp_eq_u32 s77, 7
    s_cselect_b32 s77, 0, s77
    s_lshl_b32 s78, s77, 10
    s_add_u32 s50, s85, s78
    s_mul_i32 s78, s77, 57344
    s_add_u32 s58, s86, s78
    s_lshl_b32 s77, s71, 1
    s_and_b32 s78, s70, 1
    s_add_u32 s77, s77, s78
    s_mul_i32 s77, s77, 28
    s_lshl_b32 s78, s72, 1
    s_lshr_b32 s0, s70, 1
    s_add_u32 s78, s78, s0
    s_add_u32 s100, s77, s78
    s_lshl_b32 s100, s100, 7
    s_lshl_b32 s77, s77, 3
    s_add_u32 s77, s77, s78
    s_lshl_b32 s38, s77, 10
    v_lshrrev_b32 v12, 3, v0
    v_mul_u32_u24 v12, 896, v12
    v_and_b32 v13, 7, v0
    v_lshrrev_b32 v14, 2, v0
    v_and_b32 v14, 4, v14
    v_xor_b32 v13, v13, v14
    v_lshl_add_u32 v64, v13, 4, v12
    v_lshlrev_b32 v65, 4, v0
    v_add_u32 v75, 6144, v64
    v_lshrrev_b32 v12, 2, v0
    v_and_b32 v12, 3, v12
    v_lshrrev_b32 v13, 5, v0
    v_lshl_add_u32 v13, v13, 3, v12
    v_lshlrev_b32 v13, 7, v13
    v_lshrrev_b32 v12, 1, v12
    v_lshl_add_u32 v13, v12, 6, v13
    v_and_b32 v12, 16, v0
    v_lshl_add_u32 v13, v12, 1, v13
    v_and_b32 v12, 3, v0
    v_lshl_add_u32 v13, v12, 3, v13
    s_andn2_b32 s77, 2, s70
    s_lshl_b32 s77, s77, 5
    v_xor_b32 v13, s77, v13
    v_add_u32 v66, s3, v13
    v_xor_b32 v67, 64, v66
    s_andn2_b32 s77, 1, s70
    s_mul_i32 s77, s77, 114688
    v_add_u32 v70, s77, v65
    s_sub_u32 s77, 114688, s77
    v_add_u32 v74, s77, v65
    s_and_b32 s77, s70, 1
    s_lshl_b32 s77, s77, 5
    s_lshl_b32 s78, s83, 6
    s_add_u32 s78, s78, s77
    v_and_b32 v12, 31, v0
    v_add_u32 v12, s78, v12
    s_and_b32 s77, s70, 2
    s_lshl_b32 s77, s77, 4
    s_lshl_b32 s78, s84, 6
    s_add_u32 s78, s78, s77
    v_lshrrev_b32 v13, 5, v0
    v_lshlrev_b32 v13, 2, v13
    v_add_u32 v13, s78, v13
    s_lshl_b32 s39, s78, 12
    s_lshl_b32 s77, s83, 7
    s_add_u32 s39, s39, s77
    s_and_b32 s77, s70, 1
    s_lshl_b32 s77, s77, 6
    s_add_u32 s39, s39, s77
    s_lshl_b32 s42, s78, 6
    s_add_u32 s42, s42, 114688
    v_lshrrev_b32 v69, 2, v0
    v_lshlrev_b32 v69, 12, v69
    v_and_b32 v14, 3, v0
    v_lshl_add_u32 v69, v14, 4, v69
    v_lshrrev_b32 v5, 2, v0
    v_and_b32 v5, 3, v5
    v_lshrrev_b32 v1, 5, v0
    v_lshl_add_u32 v5, v1, 2, v5
    v_lshlrev_b32 v5, 6, v5
    v_lshl_add_u32 v5, v14, 3, v5
    v_and_b32 v14, 16, v0
    v_lshl_add_u32 v5, v14, 1, v5
    v_add_u32 v127, s3, v5
    v_and_b32 v5, 15, v0
    v_lshlrev_b32 v5, 7, v5
    v_add_u32 v73, s42, v5
    v_and_b32 v5, 31, v0
    s_and_b32 s77, s70, 1
    s_mul_i32 s77, s77, 8192
    s_add_u32 s77, s77, 65536
    s_and_b32 s0, s70, 2
    s_lshl_b32 s0, s0, 5
    s_add_u32 s77, s77, s0
    v_lshrrev_b32 v14, 4, v5
    v_lshlrev_b32 v14, 12, v14
    v_and_b32 v5, 15, v5
    v_mul_u32_u24 v5, 144, v5
    v_add_u32 v14, v14, v5
    v_lshl_add_u32 v14, v1, 3, v14
    v_add_u32 v124, s77, v14
    v_lshrrev_b32 v5, 3, v0
    v_and_b32 v14, 7, v0
    v_lshlrev_b32 v14, 4, v14
    v_mul_u32_u24 v68, 896, v5
    v_add_u32 v68, v68, v14
    v_mul_u32_u24 v5, 144, v5
    v_add_u32 v5, v5, v14
    s_add_u32 s77, s3, 65536
    v_add_u32 v1, s77, v5
    s_lshl_b32 s43, s83, 2
    s_add_u32 s43, s43, s70
    s_mul_i32 s43, s43, 14336
    s_lshl_b32 s77, s84, 7
    s_add_u32 s43, s43, s77
    v_and_b32 v14, 15, v12
    v_lshrrev_b32 v12, 4, v12
    v_lshlrev_b32 v12, 7, v12
    v_lshl_add_u32 v71, v14, 2, v12
    s_mul_i32 s77, s83, 28
    s_mul_i32 s78, s70, 7
    s_add_u32 s77, s77, s78
    s_lshl_b32 s77, s77, 7
    s_add_u32 s60, s88, s77
    s_addc_u32 s61, s89, 0
    v_min_u32 v12, 27, v0
    v_mul_u32_u24 v13, 37, v12
    v_lshrrev_b32 v13, 8, v13
    v_mul_u32_u24 v14, 7, v13
    v_sub_u32 v12, v12, v14
    v_lshlrev_b32 v12, 7, v12
    v_lshl_add_u32 v12, v13, 2, v12
    v_add_u32 v72, s77, v12
    s_lshr_b32 s41, s101, 3
    s_lshl_b32 s41, s41, 2
    s_add_u32 s41, s41, s70
    s_mul_i32 s41, s41, 14336
    s_waitcnt vmcnt(4)
    s_barrier
    ds_read_b128 v[48:51], v6 offset:0
    ds_read_b64_tr_b16 v[16:17], v8 offset:0
    ds_read_b64_tr_b16 v[18:19], v8 offset:1024
    ds_read_b128 v[52:55], v6 offset:2048
    ds_read_b64_tr_b16 v[20:21], v8 offset:8192
    ds_read_b64_tr_b16 v[22:23], v8 offset:9216
    ds_read_b128 v[56:59], v6 offset:4096
    ds_read_b128 v[60:63], v6 offset:6144
    ds_read_b64_tr_b16 v[24:25], v9 offset:0
    ds_read_b64_tr_b16 v[26:27], v9 offset:1024
    ds_read_b64_tr_b16 v[28:29], v9 offset:8192
    ds_read_b64_tr_b16 v[30:31], v9 offset:9216
    s_waitcnt lgkmcnt(9)
    v_mfma_f32_16x16x32_bf16 v[128:131], v[16:19], v[48:51], 0
    ds_read_b64_tr_b16 v[32:33], v10 offset:0
    s_waitcnt lgkmcnt(9)
    v_mfma_f32_16x16x32_bf16 v[132:135], v[16:19], v[52:55], 0
    ds_read_b64_tr_b16 v[34:35], v10 offset:1024
    s_waitcnt lgkmcnt(8)
    v_mfma_f32_16x16x32_bf16 v[192:195], v[20:23], v[48:51], 0
    ds_read_b64_tr_b16 v[36:37], v10 offset:8192
    v_mfma_f32_16x16x32_bf16 v[196:199], v[20:23], v[52:55], 0
    ds_read_b64_tr_b16 v[38:39], v10 offset:9216
    s_waitcnt lgkmcnt(9)
    v_mfma_f32_16x16x32_bf16 v[144:147], v[16:19], v[56:59], 0
    ds_read_b64_tr_b16 v[40:41], v11 offset:0
    v_mfma_f32_16x16x32_bf16 v[208:211], v[20:23], v[56:59], 0
    ds_read_b64_tr_b16 v[42:43], v11 offset:1024
    s_waitcnt lgkmcnt(10)
    v_mfma_f32_16x16x32_bf16 v[148:151], v[16:19], v[60:63], 0
    ds_read_b64_tr_b16 v[44:45], v11 offset:8192
    v_mfma_f32_16x16x32_bf16 v[212:215], v[20:23], v[60:63], 0
    ds_read_b64_tr_b16 v[46:47], v11 offset:9216
    s_waitcnt lgkmcnt(10)
    v_mfma_f32_16x16x32_bf16 v[136:139], v[24:27], v[48:51], 0
    v_mfma_f32_16x16x32_bf16 v[140:143], v[24:27], v[52:55], 0
    s_add_u32 m0, s75, 65536
    s_nop 0
    buffer_load_dwordx4 v2, s[4:7], s80 offen offset:0 lds
    v_mfma_f32_16x16x32_bf16 v[152:155], v[24:27], v[56:59], 0
    v_mfma_f32_16x16x32_bf16 v[156:159], v[24:27], v[60:63], 0
    buffer_load_dwordx4 v3, s[4:7], s80 offen offset:1024 lds
    s_waitcnt lgkmcnt(8)
    v_mfma_f32_16x16x32_bf16 v[200:203], v[28:31], v[48:51], 0
    v_mfma_f32_16x16x32_bf16 v[204:207], v[28:31], v[52:55], 0
    buffer_load_dwordx4 v92, s[4:7], s80 offen offset:2048 lds
    v_mfma_f32_16x16x32_bf16 v[216:219], v[28:31], v[56:59], 0
    v_mfma_f32_16x16x32_bf16 v[220:223], v[28:31], v[60:63], 0
    buffer_load_dwordx4 v93, s[4:7], s80 offen offset:3072 lds
    s_add_u32 m0, s75, 32768
    s_nop 0
    buffer_load_dwordx4 v4, s[8:11], s82 offen offset:0 lds
    buffer_load_dwordx4 v94, s[8:11], s82 offen offset:1024 lds
    buffer_load_dwordx4 v95, s[8:11], s82 offen offset:2048 lds
    buffer_load_dwordx4 v96, s[8:11], s82 offen offset:3072 lds
    s_waitcnt lgkmcnt(6)
    v_mfma_f32_16x16x32_bf16 v[160:163], v[32:35], v[48:51], 0
    v_mfma_f32_16x16x32_bf16 v[164:167], v[32:35], v[52:55], 0
    s_waitcnt lgkmcnt(4)
    v_mfma_f32_16x16x32_bf16 v[224:227], v[36:39], v[48:51], 0
    v_mfma_f32_16x16x32_bf16 v[228:231], v[36:39], v[52:55], 0
    v_mfma_f32_16x16x32_bf16 v[176:179], v[32:35], v[56:59], 0
    v_mfma_f32_16x16x32_bf16 v[240:243], v[36:39], v[56:59], 0
    s_waitcnt lgkmcnt(0)
    s_waitcnt vmcnt(8)
    s_barrier
    ds_read_b128 v[76:79], v7 offset:0
    v_mfma_f32_16x16x32_bf16 v[180:183], v[32:35], v[60:63], 0
    ds_read_b64_tr_b16 v[16:17], v8 offset:16384
    v_mfma_f32_16x16x32_bf16 v[244:247], v[36:39], v[60:63], 0
    ds_read_b64_tr_b16 v[18:19], v8 offset:17408
    s_add_u32 m0, s75, 0
    s_add_u32 s82, s82, 114688
    buffer_load_dwordx4 v4, s[8:11], s82 offen offset:0 lds
    v_mfma_f32_16x16x32_bf16 v[168:171], v[40:43], v[48:51], 0
    ds_read_b128 v[80:83], v7 offset:2048
    v_mfma_f32_16x16x32_bf16 v[172:175], v[40:43], v[52:55], 0
    ds_read_b64_tr_b16 v[20:21], v8 offset:24576
    buffer_load_dwordx4 v94, s[8:11], s82 offen offset:1024 lds
    v_mfma_f32_16x16x32_bf16 v[184:187], v[40:43], v[56:59], 0
    ds_read_b64_tr_b16 v[22:23], v8 offset:25600
    v_mfma_f32_16x16x32_bf16 v[188:191], v[40:43], v[60:63], 0
    ds_read_b128 v[84:87], v7 offset:4096
    buffer_load_dwordx4 v95, s[8:11], s82 offen offset:2048 lds
    v_mfma_f32_16x16x32_bf16 v[232:235], v[44:47], v[48:51], 0
    ds_read_b128 v[88:91], v7 offset:6144
    v_mfma_f32_16x16x32_bf16 v[236:239], v[44:47], v[52:55], 0
    ds_read_b64_tr_b16 v[24:25], v9 offset:16384
    buffer_load_dwordx4 v96, s[8:11], s82 offen offset:3072 lds
    v_mfma_f32_16x16x32_bf16 v[248:251], v[44:47], v[56:59], 0
    ds_read_b64_tr_b16 v[26:27], v9 offset:17408
    v_mfma_f32_16x16x32_bf16 v[252:255], v[44:47], v[60:63], 0
    ds_read_b64_tr_b16 v[28:29], v9 offset:24576
    ds_read_b64_tr_b16 v[30:31], v9 offset:25600
    s_waitcnt lgkmcnt(9)
    v_mfma_f32_16x16x32_bf16 v[128:131], v[16:19], v[76:79], v[128:131]
    ds_read_b64_tr_b16 v[32:33], v10 offset:16384
    s_waitcnt lgkmcnt(9)
    v_mfma_f32_16x16x32_bf16 v[132:135], v[16:19], v[80:83], v[132:135]
    ds_read_b64_tr_b16 v[34:35], v10 offset:17408
    s_waitcnt lgkmcnt(8)
    v_mfma_f32_16x16x32_bf16 v[192:195], v[20:23], v[76:79], v[192:195]
    ds_read_b64_tr_b16 v[36:37], v10 offset:24576
    v_mfma_f32_16x16x32_bf16 v[196:199], v[20:23], v[80:83], v[196:199]
    ds_read_b64_tr_b16 v[38:39], v10 offset:25600
    s_waitcnt lgkmcnt(9)
    v_mfma_f32_16x16x32_bf16 v[144:147], v[16:19], v[84:87], v[144:147]
    ds_read_b64_tr_b16 v[40:41], v11 offset:16384
    v_mfma_f32_16x16x32_bf16 v[208:211], v[20:23], v[84:87], v[208:211]
    ds_read_b64_tr_b16 v[42:43], v11 offset:17408
    s_waitcnt lgkmcnt(10)
    v_mfma_f32_16x16x32_bf16 v[148:151], v[16:19], v[88:91], v[148:151]
    ds_read_b64_tr_b16 v[44:45], v11 offset:24576
    v_mfma_f32_16x16x32_bf16 v[212:215], v[20:23], v[88:91], v[212:215]
    ds_read_b64_tr_b16 v[46:47], v11 offset:25600
    s_waitcnt lgkmcnt(10)
    v_mfma_f32_16x16x32_bf16 v[136:139], v[24:27], v[76:79], v[136:139]
    v_mfma_f32_16x16x32_bf16 v[140:143], v[24:27], v[80:83], v[140:143]
    v_mfma_f32_16x16x32_bf16 v[152:155], v[24:27], v[84:87], v[152:155]
    v_mfma_f32_16x16x32_bf16 v[156:159], v[24:27], v[88:91], v[156:159]
    s_waitcnt lgkmcnt(8)
    v_mfma_f32_16x16x32_bf16 v[200:203], v[28:31], v[76:79], v[200:203]
    v_mfma_f32_16x16x32_bf16 v[204:207], v[28:31], v[80:83], v[204:207]
    v_mfma_f32_16x16x32_bf16 v[216:219], v[28:31], v[84:87], v[216:219]
    v_mfma_f32_16x16x32_bf16 v[220:223], v[28:31], v[88:91], v[220:223]
    s_waitcnt lgkmcnt(6)
    v_mfma_f32_16x16x32_bf16 v[160:163], v[32:35], v[76:79], v[160:163]
    v_mfma_f32_16x16x32_bf16 v[164:167], v[32:35], v[80:83], v[164:167]
    s_waitcnt lgkmcnt(4)
    v_mfma_f32_16x16x32_bf16 v[224:227], v[36:39], v[76:79], v[224:227]
    v_mfma_f32_16x16x32_bf16 v[228:231], v[36:39], v[80:83], v[228:231]
    v_mfma_f32_16x16x32_bf16 v[176:179], v[32:35], v[84:87], v[176:179]
    v_mfma_f32_16x16x32_bf16 v[240:243], v[36:39], v[84:87], v[240:243]
    s_waitcnt lgkmcnt(0)
    s_waitcnt vmcnt(4)
    s_barrier
    ds_read_b128 v[48:51], v6 offset:16384
    v_mfma_f32_16x16x32_bf16 v[180:183], v[32:35], v[88:91], v[180:183]
    ds_read_b64_tr_b16 v[16:17], v8 offset:32768
    v_mfma_f32_16x16x32_bf16 v[244:247], v[36:39], v[88:91], v[244:247]
    ds_read_b64_tr_b16 v[18:19], v8 offset:33792
    s_add_u32 m0, s75, 16384
    s_nop 0
    buffer_load_dwordx4 v4, s[8:11], s62 offen offset:0 lds
    v_mfma_f32_16x16x32_bf16 v[168:171], v[40:43], v[76:79], v[168:171]
    ds_read_b128 v[52:55], v6 offset:18432
    v_mfma_f32_16x16x32_bf16 v[172:175], v[40:43], v[80:83], v[172:175]
    ds_read_b64_tr_b16 v[20:21], v8 offset:40960
    buffer_load_dwordx4 v94, s[8:11], s62 offen offset:1024 lds
    v_mfma_f32_16x16x32_bf16 v[184:187], v[40:43], v[84:87], v[184:187]
    ds_read_b64_tr_b16 v[22:23], v8 offset:41984
    v_mfma_f32_16x16x32_bf16 v[188:191], v[40:43], v[88:91], v[188:191]
    ds_read_b128 v[56:59], v6 offset:20480
    buffer_load_dwordx4 v95, s[8:11], s62 offen offset:2048 lds
    v_mfma_f32_16x16x32_bf16 v[232:235], v[44:47], v[76:79], v[232:235]
    ds_read_b128 v[60:63], v6 offset:22528
    v_mfma_f32_16x16x32_bf16 v[236:239], v[44:47], v[80:83], v[236:239]
    ds_read_b64_tr_b16 v[24:25], v9 offset:32768
    buffer_load_dwordx4 v96, s[8:11], s62 offen offset:3072 lds
    v_mfma_f32_16x16x32_bf16 v[248:251], v[44:47], v[84:87], v[248:251]
    ds_read_b64_tr_b16 v[26:27], v9 offset:33792
    v_mfma_f32_16x16x32_bf16 v[252:255], v[44:47], v[88:91], v[252:255]
    ds_read_b64_tr_b16 v[28:29], v9 offset:40960
    s_add_u32 m0, s75, 49152
    s_nop 0
    buffer_load_dwordx4 v2, s[4:7], s36 offen offset:0 lds
    ds_read_b64_tr_b16 v[30:31], v9 offset:41984
    s_waitcnt lgkmcnt(9)
    v_mfma_f32_16x16x32_bf16 v[128:131], v[16:19], v[48:51], v[128:131]
    ds_read_b64_tr_b16 v[32:33], v10 offset:32768
    s_waitcnt lgkmcnt(9)
    v_mfma_f32_16x16x32_bf16 v[132:135], v[16:19], v[52:55], v[132:135]
    ds_read_b64_tr_b16 v[34:35], v10 offset:33792
    s_waitcnt lgkmcnt(8)
    v_mfma_f32_16x16x32_bf16 v[192:195], v[20:23], v[48:51], v[192:195]
    ds_read_b64_tr_b16 v[36:37], v10 offset:40960
    v_mfma_f32_16x16x32_bf16 v[196:199], v[20:23], v[52:55], v[196:199]
    ds_read_b64_tr_b16 v[38:39], v10 offset:41984
    s_waitcnt lgkmcnt(9)
    v_mfma_f32_16x16x32_bf16 v[144:147], v[16:19], v[56:59], v[144:147]
    ds_read_b64_tr_b16 v[40:41], v11 offset:32768
    v_mfma_f32_16x16x32_bf16 v[208:211], v[20:23], v[56:59], v[208:211]
    ds_read_b64_tr_b16 v[42:43], v11 offset:33792
    s_waitcnt lgkmcnt(10)
    v_mfma_f32_16x16x32_bf16 v[148:151], v[16:19], v[60:63], v[148:151]
    ds_read_b64_tr_b16 v[44:45], v11 offset:40960
    v_mfma_f32_16x16x32_bf16 v[212:215], v[20:23], v[60:63], v[212:215]
    ds_read_b64_tr_b16 v[46:47], v11 offset:41984
    s_waitcnt lgkmcnt(10)
    v_mfma_f32_16x16x32_bf16 v[136:139], v[24:27], v[48:51], v[136:139]
    v_mfma_f32_16x16x32_bf16 v[140:143], v[24:27], v[52:55], v[140:143]
    buffer_load_dwordx4 v3, s[4:7], s36 offen offset:1024 lds
    v_mfma_f32_16x16x32_bf16 v[152:155], v[24:27], v[56:59], v[152:155]
    v_mfma_f32_16x16x32_bf16 v[156:159], v[24:27], v[60:63], v[156:159]
    buffer_load_dwordx4 v92, s[4:7], s36 offen offset:2048 lds
    s_waitcnt lgkmcnt(8)
    v_mfma_f32_16x16x32_bf16 v[200:203], v[28:31], v[48:51], v[200:203]
    v_mfma_f32_16x16x32_bf16 v[204:207], v[28:31], v[52:55], v[204:207]
    buffer_load_dwordx4 v93, s[4:7], s36 offen offset:3072 lds
    v_mfma_f32_16x16x32_bf16 v[216:219], v[28:31], v[56:59], v[216:219]
    v_mfma_f32_16x16x32_bf16 v[220:223], v[28:31], v[60:63], v[220:223]
    s_waitcnt lgkmcnt(6)
    v_mfma_f32_16x16x32_bf16 v[160:163], v[32:35], v[48:51], v[160:163]
    v_mfma_f32_16x16x32_bf16 v[164:167], v[32:35], v[52:55], v[164:167]
    s_waitcnt lgkmcnt(4)
    v_mfma_f32_16x16x32_bf16 v[224:227], v[36:39], v[48:51], v[224:227]
    v_mfma_f32_16x16x32_bf16 v[228:231], v[36:39], v[52:55], v[228:231]
    v_mfma_f32_16x16x32_bf16 v[176:179], v[32:35], v[56:59], v[176:179]
    v_mfma_f32_16x16x32_bf16 v[240:243], v[36:39], v[56:59], v[240:243]
    s_waitcnt lgkmcnt(0)
    s_waitcnt vmcnt(8)
    s_barrier
    ds_read_b128 v[76:79], v7 offset:16384
    v_mfma_f32_16x16x32_bf16 v[180:183], v[32:35], v[60:63], v[180:183]
    ds_read_b64_tr_b16 v[16:17], v8 offset:0
    v_mfma_f32_16x16x32_bf16 v[244:247], v[36:39], v[60:63], v[244:247]
    ds_read_b64_tr_b16 v[18:19], v8 offset:1024
    s_add_u32 m0, s75, 32768
    s_add_u32 s62, s62, 114688
    buffer_load_dwordx4 v4, s[8:11], s62 offen offset:0 lds
    v_mfma_f32_16x16x32_bf16 v[168:171], v[40:43], v[48:51], v[168:171]
    ds_read_b128 v[80:83], v7 offset:18432
    v_mfma_f32_16x16x32_bf16 v[172:175], v[40:43], v[52:55], v[172:175]
    ds_read_b64_tr_b16 v[20:21], v8 offset:8192
    buffer_load_dwordx4 v94, s[8:11], s62 offen offset:1024 lds
    v_mfma_f32_16x16x32_bf16 v[184:187], v[40:43], v[56:59], v[184:187]
    ds_read_b64_tr_b16 v[22:23], v8 offset:9216
    v_mfma_f32_16x16x32_bf16 v[188:191], v[40:43], v[60:63], v[188:191]
    ds_read_b128 v[84:87], v7 offset:20480
    buffer_load_dwordx4 v95, s[8:11], s62 offen offset:2048 lds
    v_mfma_f32_16x16x32_bf16 v[232:235], v[44:47], v[48:51], v[232:235]
    ds_read_b128 v[88:91], v7 offset:22528
    v_mfma_f32_16x16x32_bf16 v[236:239], v[44:47], v[52:55], v[236:239]
    ds_read_b64_tr_b16 v[24:25], v9 offset:0
    buffer_load_dwordx4 v96, s[8:11], s62 offen offset:3072 lds
    v_mfma_f32_16x16x32_bf16 v[248:251], v[44:47], v[56:59], v[248:251]
    ds_read_b64_tr_b16 v[26:27], v9 offset:1024
    v_mfma_f32_16x16x32_bf16 v[252:255], v[44:47], v[60:63], v[252:255]
    ds_read_b64_tr_b16 v[28:29], v9 offset:8192
    ds_read_b64_tr_b16 v[30:31], v9 offset:9216
    s_waitcnt lgkmcnt(9)
    v_mfma_f32_16x16x32_bf16 v[128:131], v[16:19], v[76:79], v[128:131]
    ds_read_b64_tr_b16 v[32:33], v10 offset:0
    s_waitcnt lgkmcnt(9)
    v_mfma_f32_16x16x32_bf16 v[132:135], v[16:19], v[80:83], v[132:135]
    ds_read_b64_tr_b16 v[34:35], v10 offset:1024
    s_waitcnt lgkmcnt(8)
    v_mfma_f32_16x16x32_bf16 v[192:195], v[20:23], v[76:79], v[192:195]
    ds_read_b64_tr_b16 v[36:37], v10 offset:8192
    v_mfma_f32_16x16x32_bf16 v[196:199], v[20:23], v[80:83], v[196:199]
    ds_read_b64_tr_b16 v[38:39], v10 offset:9216
    s_waitcnt lgkmcnt(9)
    v_mfma_f32_16x16x32_bf16 v[144:147], v[16:19], v[84:87], v[144:147]
    ds_read_b64_tr_b16 v[40:41], v11 offset:0
    v_mfma_f32_16x16x32_bf16 v[208:211], v[20:23], v[84:87], v[208:211]
    ds_read_b64_tr_b16 v[42:43], v11 offset:1024
    s_waitcnt lgkmcnt(10)
    v_mfma_f32_16x16x32_bf16 v[148:151], v[16:19], v[88:91], v[148:151]
    ds_read_b64_tr_b16 v[44:45], v11 offset:8192
    v_mfma_f32_16x16x32_bf16 v[212:215], v[20:23], v[88:91], v[212:215]
    ds_read_b64_tr_b16 v[46:47], v11 offset:9216
    s_waitcnt lgkmcnt(10)
    v_mfma_f32_16x16x32_bf16 v[136:139], v[24:27], v[76:79], v[136:139]
    v_mfma_f32_16x16x32_bf16 v[140:143], v[24:27], v[80:83], v[140:143]
    v_mfma_f32_16x16x32_bf16 v[152:155], v[24:27], v[84:87], v[152:155]
    v_mfma_f32_16x16x32_bf16 v[156:159], v[24:27], v[88:91], v[156:159]
    s_waitcnt lgkmcnt(8)
    v_mfma_f32_16x16x32_bf16 v[200:203], v[28:31], v[76:79], v[200:203]
    v_mfma_f32_16x16x32_bf16 v[204:207], v[28:31], v[80:83], v[204:207]
    v_mfma_f32_16x16x32_bf16 v[216:219], v[28:31], v[84:87], v[216:219]
    v_mfma_f32_16x16x32_bf16 v[220:223], v[28:31], v[88:91], v[220:223]
    s_waitcnt lgkmcnt(6)
    v_mfma_f32_16x16x32_bf16 v[160:163], v[32:35], v[76:79], v[160:163]
    v_mfma_f32_16x16x32_bf16 v[164:167], v[32:35], v[80:83], v[164:167]
    s_waitcnt lgkmcnt(4)
    v_mfma_f32_16x16x32_bf16 v[224:227], v[36:39], v[76:79], v[224:227]
    v_mfma_f32_16x16x32_bf16 v[228:231], v[36:39], v[80:83], v[228:231]
    v_mfma_f32_16x16x32_bf16 v[176:179], v[32:35], v[84:87], v[176:179]
    v_mfma_f32_16x16x32_bf16 v[240:243], v[36:39], v[84:87], v[240:243]
    s_waitcnt lgkmcnt(0)
    s_waitcnt vmcnt(4)
    s_barrier
    ds_read_b128 v[48:51], v6 offset:0
    v_mfma_f32_16x16x32_bf16 v[180:183], v[32:35], v[88:91], v[180:183]
    ds_read_b64_tr_b16 v[16:17], v8 offset:16384
    v_mfma_f32_16x16x32_bf16 v[244:247], v[36:39], v[88:91], v[244:247]
    ds_read_b64_tr_b16 v[18:19], v8 offset:17408
    s_add_u32 m0, s75, 0
    s_nop 0
    buffer_load_dwordx4 v4, s[8:11], s63 offen offset:0 lds
    v_mfma_f32_16x16x32_bf16 v[168:171], v[40:43], v[76:79], v[168:171]
    ds_read_b128 v[52:55], v6 offset:2048
    v_mfma_f32_16x16x32_bf16 v[172:175], v[40:43], v[80:83], v[172:175]
    ds_read_b64_tr_b16 v[20:21], v8 offset:24576
    buffer_load_dwordx4 v94, s[8:11], s63 offen offset:1024 lds
    v_mfma_f32_16x16x32_bf16 v[184:187], v[40:43], v[84:87], v[184:187]
    ds_read_b64_tr_b16 v[22:23], v8 offset:25600
    v_mfma_f32_16x16x32_bf16 v[188:191], v[40:43], v[88:91], v[188:191]
    ds_read_b128 v[56:59], v6 offset:4096
    buffer_load_dwordx4 v95, s[8:11], s63 offen offset:2048 lds
    v_mfma_f32_16x16x32_bf16 v[232:235], v[44:47], v[76:79], v[232:235]
    ds_read_b128 v[60:63], v6 offset:6144
    v_mfma_f32_16x16x32_bf16 v[236:239], v[44:47], v[80:83], v[236:239]
    ds_read_b64_tr_b16 v[24:25], v9 offset:16384
    buffer_load_dwordx4 v96, s[8:11], s63 offen offset:3072 lds
    v_mfma_f32_16x16x32_bf16 v[248:251], v[44:47], v[84:87], v[248:251]
    ds_read_b64_tr_b16 v[26:27], v9 offset:17408
    v_mfma_f32_16x16x32_bf16 v[252:255], v[44:47], v[88:91], v[252:255]
    ds_read_b64_tr_b16 v[28:29], v9 offset:24576
    s_add_u32 m0, s75, 65536
    s_nop 0
    buffer_load_dwordx4 v2, s[4:7], s37 offen offset:0 lds
    ds_read_b64_tr_b16 v[30:31], v9 offset:25600
    s_waitcnt lgkmcnt(9)
    v_mfma_f32_16x16x32_bf16 v[128:131], v[16:19], v[48:51], v[128:131]
    ds_read_b64_tr_b16 v[32:33], v10 offset:16384
    s_waitcnt lgkmcnt(9)
    v_mfma_f32_16x16x32_bf16 v[132:135], v[16:19], v[52:55], v[132:135]
    ds_read_b64_tr_b16 v[34:35], v10 offset:17408
    s_waitcnt lgkmcnt(8)
    v_mfma_f32_16x16x32_bf16 v[192:195], v[20:23], v[48:51], v[192:195]
    ds_read_b64_tr_b16 v[36:37], v10 offset:24576
    v_mfma_f32_16x16x32_bf16 v[196:199], v[20:23], v[52:55], v[196:199]
    ds_read_b64_tr_b16 v[38:39], v10 offset:25600
    s_waitcnt lgkmcnt(9)
    v_mfma_f32_16x16x32_bf16 v[144:147], v[16:19], v[56:59], v[144:147]
    ds_read_b64_tr_b16 v[40:41], v11 offset:16384
    v_mfma_f32_16x16x32_bf16 v[208:211], v[20:23], v[56:59], v[208:211]
    ds_read_b64_tr_b16 v[42:43], v11 offset:17408
    s_waitcnt lgkmcnt(10)
    v_mfma_f32_16x16x32_bf16 v[148:151], v[16:19], v[60:63], v[148:151]
    ds_read_b64_tr_b16 v[44:45], v11 offset:24576
    v_mfma_f32_16x16x32_bf16 v[212:215], v[20:23], v[60:63], v[212:215]
    ds_read_b64_tr_b16 v[46:47], v11 offset:25600
    s_waitcnt lgkmcnt(10)
    v_mfma_f32_16x16x32_bf16 v[136:139], v[24:27], v[48:51], v[136:139]
    v_mfma_f32_16x16x32_bf16 v[140:143], v[24:27], v[52:55], v[140:143]
    buffer_load_dwordx4 v3, s[4:7], s37 offen offset:1024 lds
    v_mfma_f32_16x16x32_bf16 v[152:155], v[24:27], v[56:59], v[152:155]
    v_mfma_f32_16x16x32_bf16 v[156:159], v[24:27], v[60:63], v[156:159]
    buffer_load_dwordx4 v92, s[4:7], s37 offen offset:2048 lds
    s_waitcnt lgkmcnt(8)
    v_mfma_f32_16x16x32_bf16 v[200:203], v[28:31], v[48:51], v[200:203]
    v_mfma_f32_16x16x32_bf16 v[204:207], v[28:31], v[52:55], v[204:207]
    buffer_load_dwordx4 v93, s[4:7], s37 offen offset:3072 lds
    v_mfma_f32_16x16x32_bf16 v[216:219], v[28:31], v[56:59], v[216:219]
    v_mfma_f32_16x16x32_bf16 v[220:223], v[28:31], v[60:63], v[220:223]
    s_waitcnt lgkmcnt(6)
    v_mfma_f32_16x16x32_bf16 v[160:163], v[32:35], v[48:51], v[160:163]
    v_mfma_f32_16x16x32_bf16 v[164:167], v[32:35], v[52:55], v[164:167]
    s_waitcnt lgkmcnt(4)
    v_mfma_f32_16x16x32_bf16 v[224:227], v[36:39], v[48:51], v[224:227]
    v_mfma_f32_16x16x32_bf16 v[228:231], v[36:39], v[52:55], v[228:231]
    v_mfma_f32_16x16x32_bf16 v[176:179], v[32:35], v[56:59], v[176:179]
    v_mfma_f32_16x16x32_bf16 v[240:243], v[36:39], v[56:59], v[240:243]
    s_waitcnt lgkmcnt(0)
    s_waitcnt vmcnt(8)
    s_barrier
    ds_read_b128 v[76:79], v7 offset:0
    v_mfma_f32_16x16x32_bf16 v[180:183], v[32:35], v[60:63], v[180:183]
    ds_read_b64_tr_b16 v[16:17], v8 offset:32768
    v_mfma_f32_16x16x32_bf16 v[244:247], v[36:39], v[60:63], v[244:247]
    ds_read_b64_tr_b16 v[18:19], v8 offset:33792
    s_add_u32 m0, s75, 16384
    s_add_u32 s63, s63, 114688
    buffer_load_dwordx4 v4, s[8:11], s63 offen offset:0 lds
    v_mfma_f32_16x16x32_bf16 v[168:171], v[40:43], v[48:51], v[168:171]
    ds_read_b128 v[80:83], v7 offset:2048
    v_mfma_f32_16x16x32_bf16 v[172:175], v[40:43], v[52:55], v[172:175]
    ds_read_b64_tr_b16 v[20:21], v8 offset:40960
    buffer_load_dwordx4 v94, s[8:11], s63 offen offset:1024 lds
    v_mfma_f32_16x16x32_bf16 v[184:187], v[40:43], v[56:59], v[184:187]
    ds_read_b64_tr_b16 v[22:23], v8 offset:41984
    v_mfma_f32_16x16x32_bf16 v[188:191], v[40:43], v[60:63], v[188:191]
    ds_read_b128 v[84:87], v7 offset:4096
    buffer_load_dwordx4 v95, s[8:11], s63 offen offset:2048 lds
    v_mfma_f32_16x16x32_bf16 v[232:235], v[44:47], v[48:51], v[232:235]
    ds_read_b128 v[88:91], v7 offset:6144
    v_mfma_f32_16x16x32_bf16 v[236:239], v[44:47], v[52:55], v[236:239]
    ds_read_b64_tr_b16 v[24:25], v9 offset:32768
    buffer_load_dwordx4 v96, s[8:11], s63 offen offset:3072 lds
    v_mfma_f32_16x16x32_bf16 v[248:251], v[44:47], v[56:59], v[248:251]
    ds_read_b64_tr_b16 v[26:27], v9 offset:33792
    v_mfma_f32_16x16x32_bf16 v[252:255], v[44:47], v[60:63], v[252:255]
    ds_read_b64_tr_b16 v[28:29], v9 offset:40960
    s_add_u32 s77, s41, 0
    buffer_load_dwordx4 v[100:103], v65, s[16:19], s77 offen
    ds_read_b64_tr_b16 v[30:31], v9 offset:41984
    s_waitcnt lgkmcnt(9)
    v_mfma_f32_16x16x32_bf16 v[128:131], v[16:19], v[76:79], v[128:131]
    ds_read_b64_tr_b16 v[32:33], v10 offset:32768
    s_waitcnt lgkmcnt(9)
    v_mfma_f32_16x16x32_bf16 v[132:135], v[16:19], v[80:83], v[132:135]
    ds_read_b64_tr_b16 v[34:35], v10 offset:33792
    s_waitcnt lgkmcnt(8)
    v_mfma_f32_16x16x32_bf16 v[192:195], v[20:23], v[76:79], v[192:195]
    ds_read_b64_tr_b16 v[36:37], v10 offset:40960
    v_mfma_f32_16x16x32_bf16 v[196:199], v[20:23], v[80:83], v[196:199]
    ds_read_b64_tr_b16 v[38:39], v10 offset:41984
    s_waitcnt lgkmcnt(9)
    v_mfma_f32_16x16x32_bf16 v[144:147], v[16:19], v[84:87], v[144:147]
    ds_read_b64_tr_b16 v[40:41], v11 offset:32768
    v_mfma_f32_16x16x32_bf16 v[208:211], v[20:23], v[84:87], v[208:211]
    ds_read_b64_tr_b16 v[42:43], v11 offset:33792
    s_waitcnt lgkmcnt(10)
    v_mfma_f32_16x16x32_bf16 v[148:151], v[16:19], v[88:91], v[148:151]
    ds_read_b64_tr_b16 v[44:45], v11 offset:40960
    v_mfma_f32_16x16x32_bf16 v[212:215], v[20:23], v[88:91], v[212:215]
    ds_read_b64_tr_b16 v[46:47], v11 offset:41984
    s_waitcnt lgkmcnt(10)
    v_mfma_f32_16x16x32_bf16 v[136:139], v[24:27], v[76:79], v[136:139]
    v_mfma_f32_16x16x32_bf16 v[140:143], v[24:27], v[80:83], v[140:143]
    s_add_u32 s77, s41, 1024
    buffer_load_dwordx4 v[104:107], v65, s[16:19], s77 offen
    v_mfma_f32_16x16x32_bf16 v[152:155], v[24:27], v[84:87], v[152:155]
    v_mfma_f32_16x16x32_bf16 v[156:159], v[24:27], v[88:91], v[156:159]
    s_waitcnt lgkmcnt(8)
    v_mfma_f32_16x16x32_bf16 v[200:203], v[28:31], v[76:79], v[200:203]
    v_mfma_f32_16x16x32_bf16 v[204:207], v[28:31], v[80:83], v[204:207]
    v_mfma_f32_16x16x32_bf16 v[216:219], v[28:31], v[84:87], v[216:219]
    v_mfma_f32_16x16x32_bf16 v[220:223], v[28:31], v[88:91], v[220:223]
    s_waitcnt lgkmcnt(6)
    v_mfma_f32_16x16x32_bf16 v[160:163], v[32:35], v[76:79], v[160:163]
    v_mfma_f32_16x16x32_bf16 v[164:167], v[32:35], v[80:83], v[164:167]
    s_waitcnt lgkmcnt(4)
    v_mfma_f32_16x16x32_bf16 v[224:227], v[36:39], v[76:79], v[224:227]
    v_mfma_f32_16x16x32_bf16 v[228:231], v[36:39], v[80:83], v[228:231]
    v_mfma_f32_16x16x32_bf16 v[176:179], v[32:35], v[84:87], v[176:179]
    v_mfma_f32_16x16x32_bf16 v[240:243], v[36:39], v[84:87], v[240:243]
    s_waitcnt lgkmcnt(0)
    s_waitcnt vmcnt(6)
    s_barrier
    ds_read_b128 v[48:51], v6 offset:16384
    v_mfma_f32_16x16x32_bf16 v[180:183], v[32:35], v[88:91], v[180:183]
    ds_read_b64_tr_b16 v[16:17], v8 offset:0
    v_mfma_f32_16x16x32_bf16 v[244:247], v[36:39], v[88:91], v[244:247]
    ds_read_b64_tr_b16 v[18:19], v8 offset:1024
    s_add_u32 m0, s75, 32768
    s_nop 0
    buffer_load_dwordx4 v4, s[8:11], s64 offen offset:0 lds
    v_mfma_f32_16x16x32_bf16 v[168:171], v[40:43], v[76:79], v[168:171]
    ds_read_b128 v[52:55], v6 offset:18432
    v_mfma_f32_16x16x32_bf16 v[172:175], v[40:43], v[80:83], v[172:175]
    ds_read_b64_tr_b16 v[20:21], v8 offset:8192
    buffer_load_dwordx4 v94, s[8:11], s64 offen offset:1024 lds
    v_mfma_f32_16x16x32_bf16 v[184:187], v[40:43], v[84:87], v[184:187]
    ds_read_b64_tr_b16 v[22:23], v8 offset:9216
    v_mfma_f32_16x16x32_bf16 v[188:191], v[40:43], v[88:91], v[188:191]
    ds_read_b128 v[56:59], v6 offset:20480
    buffer_load_dwordx4 v95, s[8:11], s64 offen offset:2048 lds
    v_mfma_f32_16x16x32_bf16 v[232:235], v[44:47], v[76:79], v[232:235]
    ds_read_b128 v[60:63], v6 offset:22528
    v_mfma_f32_16x16x32_bf16 v[236:239], v[44:47], v[80:83], v[236:239]
    ds_read_b64_tr_b16 v[24:25], v9 offset:0
    buffer_load_dwordx4 v96, s[8:11], s64 offen offset:3072 lds
    v_mfma_f32_16x16x32_bf16 v[248:251], v[44:47], v[84:87], v[248:251]
    ds_read_b64_tr_b16 v[26:27], v9 offset:1024
    v_mfma_f32_16x16x32_bf16 v[252:255], v[44:47], v[88:91], v[252:255]
    ds_read_b64_tr_b16 v[28:29], v9 offset:8192
    s_add_u32 m0, s75, 49152
    s_nop 0
    buffer_load_dwordx4 v2, s[4:7], s51 offen offset:0 lds
    ds_read_b64_tr_b16 v[30:31], v9 offset:9216
    s_waitcnt lgkmcnt(9)
    v_mfma_f32_16x16x32_bf16 v[128:131], v[16:19], v[48:51], v[128:131]
    ds_read_b64_tr_b16 v[32:33], v10 offset:0
    s_waitcnt lgkmcnt(9)
    v_mfma_f32_16x16x32_bf16 v[132:135], v[16:19], v[52:55], v[132:135]
    ds_read_b64_tr_b16 v[34:35], v10 offset:1024
    s_waitcnt lgkmcnt(8)
    v_mfma_f32_16x16x32_bf16 v[192:195], v[20:23], v[48:51], v[192:195]
    ds_read_b64_tr_b16 v[36:37], v10 offset:8192
    v_mfma_f32_16x16x32_bf16 v[196:199], v[20:23], v[52:55], v[196:199]
    ds_read_b64_tr_b16 v[38:39], v10 offset:9216
    s_waitcnt lgkmcnt(9)
    v_mfma_f32_16x16x32_bf16 v[144:147], v[16:19], v[56:59], v[144:147]
    ds_read_b64_tr_b16 v[40:41], v11 offset:0
    v_mfma_f32_16x16x32_bf16 v[208:211], v[20:23], v[56:59], v[208:211]
    ds_read_b64_tr_b16 v[42:43], v11 offset:1024
    s_waitcnt lgkmcnt(10)
    v_mfma_f32_16x16x32_bf16 v[148:151], v[16:19], v[60:63], v[148:151]
    ds_read_b64_tr_b16 v[44:45], v11 offset:8192
    v_mfma_f32_16x16x32_bf16 v[212:215], v[20:23], v[60:63], v[212:215]
    ds_read_b64_tr_b16 v[46:47], v11 offset:9216
    s_waitcnt lgkmcnt(10)
    v_mfma_f32_16x16x32_bf16 v[136:139], v[24:27], v[48:51], v[136:139]
    v_mfma_f32_16x16x32_bf16 v[140:143], v[24:27], v[52:55], v[140:143]
    buffer_load_dwordx4 v3, s[4:7], s51 offen offset:1024 lds
    v_mfma_f32_16x16x32_bf16 v[152:155], v[24:27], v[56:59], v[152:155]
    v_mfma_f32_16x16x32_bf16 v[156:159], v[24:27], v[60:63], v[156:159]
    buffer_load_dwordx4 v92, s[4:7], s51 offen offset:2048 lds
    s_waitcnt lgkmcnt(8)
    v_mfma_f32_16x16x32_bf16 v[200:203], v[28:31], v[48:51], v[200:203]
    v_mfma_f32_16x16x32_bf16 v[204:207], v[28:31], v[52:55], v[204:207]
    buffer_load_dwordx4 v93, s[4:7], s51 offen offset:3072 lds
    v_mfma_f32_16x16x32_bf16 v[216:219], v[28:31], v[56:59], v[216:219]
    v_mfma_f32_16x16x32_bf16 v[220:223], v[28:31], v[60:63], v[220:223]
    s_add_u32 s77, s41, 2048
    buffer_load_dwordx4 v[108:111], v65, s[16:19], s77 offen
    s_add_u32 s77, s41, 3072
    buffer_load_dwordx4 v[112:115], v65, s[16:19], s77 offen
    s_waitcnt lgkmcnt(6)
    v_mfma_f32_16x16x32_bf16 v[160:163], v[32:35], v[48:51], v[160:163]
    v_mfma_f32_16x16x32_bf16 v[164:167], v[32:35], v[52:55], v[164:167]
    s_waitcnt lgkmcnt(4)
    v_mfma_f32_16x16x32_bf16 v[224:227], v[36:39], v[48:51], v[224:227]
    v_mfma_f32_16x16x32_bf16 v[228:231], v[36:39], v[52:55], v[228:231]
    v_mfma_f32_16x16x32_bf16 v[176:179], v[32:35], v[56:59], v[176:179]
    v_mfma_f32_16x16x32_bf16 v[240:243], v[36:39], v[56:59], v[240:243]
    s_waitcnt lgkmcnt(0)
    s_waitcnt vmcnt(12)
    s_barrier
    ds_read_b128 v[76:79], v7 offset:16384
    v_mfma_f32_16x16x32_bf16 v[180:183], v[32:35], v[60:63], v[180:183]
    ds_read_b64_tr_b16 v[16:17], v8 offset:16384
    v_mfma_f32_16x16x32_bf16 v[244:247], v[36:39], v[60:63], v[244:247]
    ds_read_b64_tr_b16 v[18:19], v8 offset:17408
    s_add_u32 m0, s75, 0
    s_add_u32 s64, s64, 114688
    buffer_load_dwordx4 v4, s[8:11], s64 offen offset:0 lds
    v_mfma_f32_16x16x32_bf16 v[168:171], v[40:43], v[48:51], v[168:171]
    ds_read_b128 v[80:83], v7 offset:18432
    v_mfma_f32_16x16x32_bf16 v[172:175], v[40:43], v[52:55], v[172:175]
    ds_read_b64_tr_b16 v[20:21], v8 offset:24576
    buffer_load_dwordx4 v94, s[8:11], s64 offen offset:1024 lds
    v_mfma_f32_16x16x32_bf16 v[184:187], v[40:43], v[56:59], v[184:187]
    ds_read_b64_tr_b16 v[22:23], v8 offset:25600
    v_mfma_f32_16x16x32_bf16 v[188:191], v[40:43], v[60:63], v[188:191]
    ds_read_b128 v[84:87], v7 offset:20480
    buffer_load_dwordx4 v95, s[8:11], s64 offen offset:2048 lds
    v_mfma_f32_16x16x32_bf16 v[232:235], v[44:47], v[48:51], v[232:235]
    ds_read_b128 v[88:91], v7 offset:22528
    v_mfma_f32_16x16x32_bf16 v[236:239], v[44:47], v[52:55], v[236:239]
    ds_read_b64_tr_b16 v[24:25], v9 offset:16384
    buffer_load_dwordx4 v96, s[8:11], s64 offen offset:3072 lds
    v_mfma_f32_16x16x32_bf16 v[248:251], v[44:47], v[56:59], v[248:251]
    ds_read_b64_tr_b16 v[26:27], v9 offset:17408
    v_mfma_f32_16x16x32_bf16 v[252:255], v[44:47], v[60:63], v[252:255]
    ds_read_b64_tr_b16 v[28:29], v9 offset:24576
    s_add_u32 s77, s41, 4096
    buffer_load_dwordx4 v[100:103], v65, s[16:19], s77 offen
    ds_read_b64_tr_b16 v[30:31], v9 offset:25600
    s_waitcnt lgkmcnt(9)
    v_mfma_f32_16x16x32_bf16 v[128:131], v[16:19], v[76:79], v[128:131]
    ds_read_b64_tr_b16 v[32:33], v10 offset:16384
    s_waitcnt lgkmcnt(9)
    v_mfma_f32_16x16x32_bf16 v[132:135], v[16:19], v[80:83], v[132:135]
    ds_read_b64_tr_b16 v[34:35], v10 offset:17408
    s_waitcnt lgkmcnt(8)
    v_mfma_f32_16x16x32_bf16 v[192:195], v[20:23], v[76:79], v[192:195]
    ds_read_b64_tr_b16 v[36:37], v10 offset:24576
    v_mfma_f32_16x16x32_bf16 v[196:199], v[20:23], v[80:83], v[196:199]
    ds_read_b64_tr_b16 v[38:39], v10 offset:25600
    s_waitcnt lgkmcnt(9)
    v_mfma_f32_16x16x32_bf16 v[144:147], v[16:19], v[84:87], v[144:147]
    ds_read_b64_tr_b16 v[40:41], v11 offset:16384
    v_mfma_f32_16x16x32_bf16 v[208:211], v[20:23], v[84:87], v[208:211]
    ds_read_b64_tr_b16 v[42:43], v11 offset:17408
    s_waitcnt lgkmcnt(10)
    v_mfma_f32_16x16x32_bf16 v[148:151], v[16:19], v[88:91], v[148:151]
    ds_read_b64_tr_b16 v[44:45], v11 offset:24576
    v_mfma_f32_16x16x32_bf16 v[212:215], v[20:23], v[88:91], v[212:215]
    ds_read_b64_tr_b16 v[46:47], v11 offset:25600
    s_waitcnt lgkmcnt(10)
    v_mfma_f32_16x16x32_bf16 v[136:139], v[24:27], v[76:79], v[136:139]
    v_mfma_f32_16x16x32_bf16 v[140:143], v[24:27], v[80:83], v[140:143]
    s_add_u32 s77, s41, 5120
    buffer_load_dwordx4 v[104:107], v65, s[16:19], s77 offen
    v_mfma_f32_16x16x32_bf16 v[152:155], v[24:27], v[84:87], v[152:155]
    v_mfma_f32_16x16x32_bf16 v[156:159], v[24:27], v[88:91], v[156:159]
    s_waitcnt lgkmcnt(8)
    v_mfma_f32_16x16x32_bf16 v[200:203], v[28:31], v[76:79], v[200:203]
    v_mfma_f32_16x16x32_bf16 v[204:207], v[28:31], v[80:83], v[204:207]
    v_mfma_f32_16x16x32_bf16 v[216:219], v[28:31], v[84:87], v[216:219]
    v_mfma_f32_16x16x32_bf16 v[220:223], v[28:31], v[88:91], v[220:223]
    s_waitcnt lgkmcnt(6)
    v_mfma_f32_16x16x32_bf16 v[160:163], v[32:35], v[76:79], v[160:163]
    v_mfma_f32_16x16x32_bf16 v[164:167], v[32:35], v[80:83], v[164:167]
    s_waitcnt lgkmcnt(4)
    v_mfma_f32_16x16x32_bf16 v[224:227], v[36:39], v[76:79], v[224:227]
    v_mfma_f32_16x16x32_bf16 v[228:231], v[36:39], v[80:83], v[228:231]
    v_mfma_f32_16x16x32_bf16 v[176:179], v[32:35], v[84:87], v[176:179]
    v_mfma_f32_16x16x32_bf16 v[240:243], v[36:39], v[84:87], v[240:243]
    s_waitcnt lgkmcnt(0)
    s_waitcnt vmcnt(8)
    s_barrier
    ds_read_b128 v[48:51], v6 offset:0
    v_mfma_f32_16x16x32_bf16 v[180:183], v[32:35], v[88:91], v[180:183]
    ds_read_b64_tr_b16 v[16:17], v8 offset:32768
    v_mfma_f32_16x16x32_bf16 v[244:247], v[36:39], v[88:91], v[244:247]
    ds_read_b64_tr_b16 v[18:19], v8 offset:33792
    s_add_u32 m0, s75, 16384
    s_nop 0
    buffer_load_dwordx4 v4, s[8:11], s65 offen offset:0 lds
    v_mfma_f32_16x16x32_bf16 v[168:171], v[40:43], v[76:79], v[168:171]
    ds_read_b128 v[52:55], v6 offset:2048
    v_mfma_f32_16x16x32_bf16 v[172:175], v[40:43], v[80:83], v[172:175]
    ds_read_b64_tr_b16 v[20:21], v8 offset:40960
    buffer_load_dwordx4 v94, s[8:11], s65 offen offset:1024 lds
    v_mfma_f32_16x16x32_bf16 v[184:187], v[40:43], v[84:87], v[184:187]
    ds_read_b64_tr_b16 v[22:23], v8 offset:41984
    v_mfma_f32_16x16x32_bf16 v[188:191], v[40:43], v[88:91], v[188:191]
    ds_read_b128 v[56:59], v6 offset:4096
    buffer_load_dwordx4 v95, s[8:11], s65 offen offset:2048 lds
    v_mfma_f32_16x16x32_bf16 v[232:235], v[44:47], v[76:79], v[232:235]
    ds_read_b128 v[60:63], v6 offset:6144
    v_mfma_f32_16x16x32_bf16 v[236:239], v[44:47], v[80:83], v[236:239]
    ds_read_b64_tr_b16 v[24:25], v9 offset:32768
    buffer_load_dwordx4 v96, s[8:11], s65 offen offset:3072 lds
    v_mfma_f32_16x16x32_bf16 v[248:251], v[44:47], v[84:87], v[248:251]
    ds_read_b64_tr_b16 v[26:27], v9 offset:33792
    v_mfma_f32_16x16x32_bf16 v[252:255], v[44:47], v[88:91], v[252:255]
    ds_read_b64_tr_b16 v[28:29], v9 offset:40960
    s_add_u32 m0, s75, 65536
    s_nop 0
    buffer_load_dwordx4 v2, s[4:7], s73 offen offset:0 lds
    ds_read_b64_tr_b16 v[30:31], v9 offset:41984
    s_waitcnt lgkmcnt(9)
    v_mfma_f32_16x16x32_bf16 v[128:131], v[16:19], v[48:51], v[128:131]
    ds_read_b64_tr_b16 v[32:33], v10 offset:32768
    s_waitcnt lgkmcnt(9)
    v_mfma_f32_16x16x32_bf16 v[132:135], v[16:19], v[52:55], v[132:135]
    ds_read_b64_tr_b16 v[34:35], v10 offset:33792
    s_waitcnt lgkmcnt(8)
    v_mfma_f32_16x16x32_bf16 v[192:195], v[20:23], v[48:51], v[192:195]
    ds_read_b64_tr_b16 v[36:37], v10 offset:40960
    v_mfma_f32_16x16x32_bf16 v[196:199], v[20:23], v[52:55], v[196:199]
    ds_read_b64_tr_b16 v[38:39], v10 offset:41984
    s_waitcnt lgkmcnt(9)
    v_mfma_f32_16x16x32_bf16 v[144:147], v[16:19], v[56:59], v[144:147]
    ds_read_b64_tr_b16 v[40:41], v11 offset:32768
    v_mfma_f32_16x16x32_bf16 v[208:211], v[20:23], v[56:59], v[208:211]
    ds_read_b64_tr_b16 v[42:43], v11 offset:33792
    s_waitcnt lgkmcnt(10)
    v_mfma_f32_16x16x32_bf16 v[148:151], v[16:19], v[60:63], v[148:151]
    ds_read_b64_tr_b16 v[44:45], v11 offset:40960
    v_mfma_f32_16x16x32_bf16 v[212:215], v[20:23], v[60:63], v[212:215]
    ds_read_b64_tr_b16 v[46:47], v11 offset:41984
    s_waitcnt lgkmcnt(10)
    v_mfma_f32_16x16x32_bf16 v[136:139], v[24:27], v[48:51], v[136:139]
    v_mfma_f32_16x16x32_bf16 v[140:143], v[24:27], v[52:55], v[140:143]
    buffer_load_dwordx4 v3, s[4:7], s73 offen offset:1024 lds
    v_mfma_f32_16x16x32_bf16 v[152:155], v[24:27], v[56:59], v[152:155]
    v_mfma_f32_16x16x32_bf16 v[156:159], v[24:27], v[60:63], v[156:159]
    buffer_load_dwordx4 v92, s[4:7], s73 offen offset:2048 lds
    s_waitcnt lgkmcnt(8)
    v_mfma_f32_16x16x32_bf16 v[200:203], v[28:31], v[48:51], v[200:203]
    v_mfma_f32_16x16x32_bf16 v[204:207], v[28:31], v[52:55], v[204:207]
    buffer_load_dwordx4 v93, s[4:7], s73 offen offset:3072 lds
    v_mfma_f32_16x16x32_bf16 v[216:219], v[28:31], v[56:59], v[216:219]
    v_mfma_f32_16x16x32_bf16 v[220:223], v[28:31], v[60:63], v[220:223]
    s_add_u32 s77, s41, 6144
    buffer_load_dwordx4 v[108:111], v65, s[16:19], s77 offen
    s_add_u32 s77, s41, 7168
    buffer_load_dwordx4 v[112:115], v65, s[16:19], s77 offen
    v_mov_b32 v12, 0
    buffer_load_dword v13, v12, s[92:95], 0 offen sc1
    s_waitcnt lgkmcnt(6)
    v_mfma_f32_16x16x32_bf16 v[160:163], v[32:35], v[48:51], v[160:163]
    v_mfma_f32_16x16x32_bf16 v[164:167], v[32:35], v[52:55], v[164:167]
    s_waitcnt lgkmcnt(4)
    v_mfma_f32_16x16x32_bf16 v[224:227], v[36:39], v[48:51], v[224:227]
    v_mfma_f32_16x16x32_bf16 v[228:231], v[36:39], v[52:55], v[228:231]
    v_mfma_f32_16x16x32_bf16 v[176:179], v[32:35], v[56:59], v[176:179]
    v_mfma_f32_16x16x32_bf16 v[240:243], v[36:39], v[56:59], v[240:243]
    s_waitcnt lgkmcnt(0)
    s_waitcnt vmcnt(13)
    s_barrier
    ds_read_b128 v[76:79], v7 offset:0
    v_mfma_f32_16x16x32_bf16 v[180:183], v[32:35], v[60:63], v[180:183]
    ds_read_b64_tr_b16 v[16:17], v8 offset:0
    v_mfma_f32_16x16x32_bf16 v[244:247], v[36:39], v[60:63], v[244:247]
    ds_read_b64_tr_b16 v[18:19], v8 offset:1024
    s_add_u32 m0, s75, 32768
    s_add_u32 s65, s65, 114688
    buffer_load_dwordx4 v4, s[8:11], s65 offen offset:0 lds
    v_mfma_f32_16x16x32_bf16 v[168:171], v[40:43], v[48:51], v[168:171]
    ds_read_b128 v[80:83], v7 offset:2048
    v_mfma_f32_16x16x32_bf16 v[172:175], v[40:43], v[52:55], v[172:175]
    ds_read_b64_tr_b16 v[20:21], v8 offset:8192
    buffer_load_dwordx4 v94, s[8:11], s65 offen offset:1024 lds
    v_mfma_f32_16x16x32_bf16 v[184:187], v[40:43], v[56:59], v[184:187]
    ds_read_b64_tr_b16 v[22:23], v8 offset:9216
    v_mfma_f32_16x16x32_bf16 v[188:191], v[40:43], v[60:63], v[188:191]
    ds_read_b128 v[84:87], v7 offset:4096
    buffer_load_dwordx4 v95, s[8:11], s65 offen offset:2048 lds
    v_mfma_f32_16x16x32_bf16 v[232:235], v[44:47], v[48:51], v[232:235]
    ds_read_b128 v[88:91], v7 offset:6144
    v_mfma_f32_16x16x32_bf16 v[236:239], v[44:47], v[52:55], v[236:239]
    ds_read_b64_tr_b16 v[24:25], v9 offset:0
    buffer_load_dwordx4 v96, s[8:11], s65 offen offset:3072 lds
    v_mfma_f32_16x16x32_bf16 v[248:251], v[44:47], v[56:59], v[248:251]
    ds_read_b64_tr_b16 v[26:27], v9 offset:1024
    v_mfma_f32_16x16x32_bf16 v[252:255], v[44:47], v[60:63], v[252:255]
    ds_read_b64_tr_b16 v[28:29], v9 offset:8192
    s_add_u32 s77, s41, 8192
    buffer_load_dwordx4 v[100:103], v65, s[16:19], s77 offen
    ds_read_b64_tr_b16 v[30:31], v9 offset:9216
    s_waitcnt lgkmcnt(9)
    v_mfma_f32_16x16x32_bf16 v[128:131], v[16:19], v[76:79], v[128:131]
    ds_read_b64_tr_b16 v[32:33], v10 offset:0
    s_waitcnt lgkmcnt(9)
    v_mfma_f32_16x16x32_bf16 v[132:135], v[16:19], v[80:83], v[132:135]
    ds_read_b64_tr_b16 v[34:35], v10 offset:1024
    s_waitcnt lgkmcnt(8)
    v_mfma_f32_16x16x32_bf16 v[192:195], v[20:23], v[76:79], v[192:195]
    ds_read_b64_tr_b16 v[36:37], v10 offset:8192
    v_mfma_f32_16x16x32_bf16 v[196:199], v[20:23], v[80:83], v[196:199]
    ds_read_b64_tr_b16 v[38:39], v10 offset:9216
    s_waitcnt lgkmcnt(9)
    v_mfma_f32_16x16x32_bf16 v[144:147], v[16:19], v[84:87], v[144:147]
    ds_read_b64_tr_b16 v[40:41], v11 offset:0
    v_mfma_f32_16x16x32_bf16 v[208:211], v[20:23], v[84:87], v[208:211]
    ds_read_b64_tr_b16 v[42:43], v11 offset:1024
    s_waitcnt lgkmcnt(10)
    v_mfma_f32_16x16x32_bf16 v[148:151], v[16:19], v[88:91], v[148:151]
    ds_read_b64_tr_b16 v[44:45], v11 offset:8192
    v_mfma_f32_16x16x32_bf16 v[212:215], v[20:23], v[88:91], v[212:215]
    ds_read_b64_tr_b16 v[46:47], v11 offset:9216
    s_waitcnt lgkmcnt(10)
    v_mfma_f32_16x16x32_bf16 v[136:139], v[24:27], v[76:79], v[136:139]
    v_mfma_f32_16x16x32_bf16 v[140:143], v[24:27], v[80:83], v[140:143]
    s_add_u32 s77, s41, 9216
    buffer_load_dwordx4 v[104:107], v65, s[16:19], s77 offen
    v_mfma_f32_16x16x32_bf16 v[152:155], v[24:27], v[84:87], v[152:155]
    v_mfma_f32_16x16x32_bf16 v[156:159], v[24:27], v[88:91], v[156:159]
    s_waitcnt lgkmcnt(8)
    v_mfma_f32_16x16x32_bf16 v[200:203], v[28:31], v[76:79], v[200:203]
    v_mfma_f32_16x16x32_bf16 v[204:207], v[28:31], v[80:83], v[204:207]
    v_mfma_f32_16x16x32_bf16 v[216:219], v[28:31], v[84:87], v[216:219]
    v_mfma_f32_16x16x32_bf16 v[220:223], v[28:31], v[88:91], v[220:223]
    s_waitcnt lgkmcnt(6)
    v_mfma_f32_16x16x32_bf16 v[160:163], v[32:35], v[76:79], v[160:163]
    v_mfma_f32_16x16x32_bf16 v[164:167], v[32:35], v[80:83], v[164:167]
    s_waitcnt lgkmcnt(4)
    v_mfma_f32_16x16x32_bf16 v[224:227], v[36:39], v[76:79], v[224:227]
    v_mfma_f32_16x16x32_bf16 v[228:231], v[36:39], v[80:83], v[228:231]
    v_mfma_f32_16x16x32_bf16 v[176:179], v[32:35], v[84:87], v[176:179]
    v_mfma_f32_16x16x32_bf16 v[240:243], v[36:39], v[84:87], v[240:243]
    s_waitcnt lgkmcnt(0)
    s_waitcnt vmcnt(9)
    s_barrier
    ds_read_b128 v[48:51], v6 offset:16384
    v_mfma_f32_16x16x32_bf16 v[180:183], v[32:35], v[88:91], v[180:183]
    ds_read_b64_tr_b16 v[16:17], v8 offset:16384
    v_mfma_f32_16x16x32_bf16 v[244:247], v[36:39], v[88:91], v[244:247]
    ds_read_b64_tr_b16 v[18:19], v8 offset:17408
    s_add_u32 m0, s75, 0
    s_nop 0
    buffer_load_dwordx4 v4, s[8:11], s76 offen offset:0 lds
    v_mfma_f32_16x16x32_bf16 v[168:171], v[40:43], v[76:79], v[168:171]
    ds_read_b128 v[52:55], v6 offset:18432
    v_mfma_f32_16x16x32_bf16 v[172:175], v[40:43], v[80:83], v[172:175]
    ds_read_b64_tr_b16 v[20:21], v8 offset:24576
    buffer_load_dwordx4 v94, s[8:11], s76 offen offset:1024 lds
    v_mfma_f32_16x16x32_bf16 v[184:187], v[40:43], v[84:87], v[184:187]
    ds_read_b64_tr_b16 v[22:23], v8 offset:25600
    v_mfma_f32_16x16x32_bf16 v[188:191], v[40:43], v[88:91], v[188:191]
    ds_read_b128 v[56:59], v6 offset:20480
    buffer_load_dwordx4 v95, s[8:11], s76 offen offset:2048 lds
    v_mfma_f32_16x16x32_bf16 v[232:235], v[44:47], v[76:79], v[232:235]
    ds_read_b128 v[60:63], v6 offset:22528
    v_mfma_f32_16x16x32_bf16 v[236:239], v[44:47], v[80:83], v[236:239]
    ds_read_b64_tr_b16 v[24:25], v9 offset:16384
    buffer_load_dwordx4 v96, s[8:11], s76 offen offset:3072 lds
    v_mfma_f32_16x16x32_bf16 v[248:251], v[44:47], v[84:87], v[248:251]
    ds_read_b64_tr_b16 v[26:27], v9 offset:17408
    v_mfma_f32_16x16x32_bf16 v[252:255], v[44:47], v[88:91], v[252:255]
    ds_read_b64_tr_b16 v[28:29], v9 offset:24576
    s_add_u32 m0, s75, 49152
    s_nop 0
    buffer_load_dwordx4 v2, s[4:7], s74 offen offset:0 lds
    ds_read_b64_tr_b16 v[30:31], v9 offset:25600
    s_lshr_b32 s77, s101, 3
    s_lshl_b32 s77, s77, 2
    v_mov_b32 v14, 1
    v_lshlrev_b32 v5, 20, v0
    s_cmp_lg_u32 s70, 0
    s_cbranch_scc1 L_mf1
    buffer_store_dword v14, v5, s[92:95], s77 offen offset:128
L_mf1:
    s_waitcnt lgkmcnt(9)
    v_mfma_f32_16x16x32_bf16 v[128:131], v[16:19], v[48:51], v[128:131]
    ds_read_b64_tr_b16 v[32:33], v10 offset:16384
    s_waitcnt lgkmcnt(9)
    v_mfma_f32_16x16x32_bf16 v[132:135], v[16:19], v[52:55], v[132:135]
    ds_read_b64_tr_b16 v[34:35], v10 offset:17408
    s_waitcnt lgkmcnt(8)
    v_mfma_f32_16x16x32_bf16 v[192:195], v[20:23], v[48:51], v[192:195]
    ds_read_b64_tr_b16 v[36:37], v10 offset:24576
    v_mfma_f32_16x16x32_bf16 v[196:199], v[20:23], v[52:55], v[196:199]
    ds_read_b64_tr_b16 v[38:39], v10 offset:25600
    s_waitcnt lgkmcnt(9)
    v_mfma_f32_16x16x32_bf16 v[144:147], v[16:19], v[56:59], v[144:147]
    ds_read_b64_tr_b16 v[40:41], v11 offset:16384
    v_mfma_f32_16x16x32_bf16 v[208:211], v[20:23], v[56:59], v[208:211]
    ds_read_b64_tr_b16 v[42:43], v11 offset:17408
    s_waitcnt lgkmcnt(10)
    v_mfma_f32_16x16x32_bf16 v[148:151], v[16:19], v[60:63], v[148:151]
    ds_read_b64_tr_b16 v[44:45], v11 offset:24576
    v_mfma_f32_16x16x32_bf16 v[212:215], v[20:23], v[60:63], v[212:215]
    ds_read_b64_tr_b16 v[46:47], v11 offset:25600
    s_waitcnt lgkmcnt(10)
    v_mfma_f32_16x16x32_bf16 v[136:139], v[24:27], v[48:51], v[136:139]
    v_mfma_f32_16x16x32_bf16 v[140:143], v[24:27], v[52:55], v[140:143]
    buffer_load_dwordx4 v3, s[4:7], s74 offen offset:1024 lds
    v_mfma_f32_16x16x32_bf16 v[152:155], v[24:27], v[56:59], v[152:155]
    v_mfma_f32_16x16x32_bf16 v[156:159], v[24:27], v[60:63], v[156:159]
    buffer_load_dwordx4 v92, s[4:7], s74 offen offset:2048 lds
    s_waitcnt lgkmcnt(8)
    v_mfma_f32_16x16x32_bf16 v[200:203], v[28:31], v[48:51], v[200:203]
    v_mfma_f32_16x16x32_bf16 v[204:207], v[28:31], v[52:55], v[204:207]
    buffer_load_dwordx4 v93, s[4:7], s74 offen offset:3072 lds
    v_mfma_f32_16x16x32_bf16 v[216:219], v[28:31], v[56:59], v[216:219]
    v_mfma_f32_16x16x32_bf16 v[220:223], v[28:31], v[60:63], v[220:223]
    s_add_u32 s77, s41, 10240
    buffer_load_dwordx4 v[108:111], v65, s[16:19], s77 offen
    s_waitcnt lgkmcnt(6)
    v_mfma_f32_16x16x32_bf16 v[160:163], v[32:35], v[48:51], v[160:163]
    v_mfma_f32_16x16x32_bf16 v[164:167], v[32:35], v[52:55], v[164:167]
    s_waitcnt lgkmcnt(4)
    v_mfma_f32_16x16x32_bf16 v[224:227], v[36:39], v[48:51], v[224:227]
    v_mfma_f32_16x16x32_bf16 v[228:231], v[36:39], v[52:55], v[228:231]
    v_mfma_f32_16x16x32_bf16 v[176:179], v[32:35], v[56:59], v[176:179]
    v_mfma_f32_16x16x32_bf16 v[240:243], v[36:39], v[56:59], v[240:243]
    s_waitcnt lgkmcnt(0)
    s_waitcnt vmcnt(11)
    s_barrier
    ds_read_b128 v[76:79], v7 offset:16384
    v_mfma_f32_16x16x32_bf16 v[180:183], v[32:35], v[60:63], v[180:183]
    ds_read_b64_tr_b16 v[16:17], v8 offset:32768
    v_mfma_f32_16x16x32_bf16 v[244:247], v[36:39], v[60:63], v[244:247]
    ds_read_b64_tr_b16 v[18:19], v8 offset:33792
    s_add_u32 m0, s75, 16384
    s_add_u32 s76, s76, 114688
    buffer_load_dwordx4 v4, s[8:11], s76 offen offset:0 lds
    v_mfma_f32_16x16x32_bf16 v[168:171], v[40:43], v[48:51], v[168:171]
    ds_read_b128 v[80:83], v7 offset:18432
    v_mfma_f32_16x16x32_bf16 v[172:175], v[40:43], v[52:55], v[172:175]
    ds_read_b64_tr_b16 v[20:21], v8 offset:40960
    buffer_load_dwordx4 v94, s[8:11], s76 offen offset:1024 lds
    v_mfma_f32_16x16x32_bf16 v[184:187], v[40:43], v[56:59], v[184:187]
    ds_read_b64_tr_b16 v[22:23], v8 offset:41984
    v_mfma_f32_16x16x32_bf16 v[188:191], v[40:43], v[60:63], v[188:191]
    ds_read_b128 v[84:87], v7 offset:20480
    buffer_load_dwordx4 v95, s[8:11], s76 offen offset:2048 lds
    v_mfma_f32_16x16x32_bf16 v[232:235], v[44:47], v[48:51], v[232:235]
    ds_read_b128 v[88:91], v7 offset:22528
    v_mfma_f32_16x16x32_bf16 v[236:239], v[44:47], v[52:55], v[236:239]
    ds_read_b64_tr_b16 v[24:25], v9 offset:32768
    buffer_load_dwordx4 v96, s[8:11], s76 offen offset:3072 lds
    v_mfma_f32_16x16x32_bf16 v[248:251], v[44:47], v[56:59], v[248:251]
    ds_read_b64_tr_b16 v[26:27], v9 offset:33792
    v_mfma_f32_16x16x32_bf16 v[252:255], v[44:47], v[60:63], v[252:255]
    ds_read_b64_tr_b16 v[28:29], v9 offset:40960
    s_add_u32 s77, s41, 11264
    buffer_load_dwordx4 v[112:115], v65, s[16:19], s77 offen
    ds_read_b64_tr_b16 v[30:31], v9 offset:41984
    s_waitcnt lgkmcnt(9)
    v_mfma_f32_16x16x32_bf16 v[128:131], v[16:19], v[76:79], v[128:131]
    ds_read_b64_tr_b16 v[32:33], v10 offset:32768
    s_waitcnt lgkmcnt(9)
    v_mfma_f32_16x16x32_bf16 v[132:135], v[16:19], v[80:83], v[132:135]
    ds_read_b64_tr_b16 v[34:35], v10 offset:33792
    s_waitcnt lgkmcnt(8)
    v_mfma_f32_16x16x32_bf16 v[192:195], v[20:23], v[76:79], v[192:195]
    ds_read_b64_tr_b16 v[36:37], v10 offset:40960
    v_mfma_f32_16x16x32_bf16 v[196:199], v[20:23], v[80:83], v[196:199]
    ds_read_b64_tr_b16 v[38:39], v10 offset:41984
    s_waitcnt lgkmcnt(9)
    v_mfma_f32_16x16x32_bf16 v[144:147], v[16:19], v[84:87], v[144:147]
    ds_read_b64_tr_b16 v[40:41], v11 offset:32768
    v_mfma_f32_16x16x32_bf16 v[208:211], v[20:23], v[84:87], v[208:211]
    ds_read_b64_tr_b16 v[42:43], v11 offset:33792
    s_waitcnt lgkmcnt(10)
    v_mfma_f32_16x16x32_bf16 v[148:151], v[16:19], v[88:91], v[148:151]
    ds_read_b64_tr_b16 v[44:45], v11 offset:40960
    v_mfma_f32_16x16x32_bf16 v[212:215], v[20:23], v[88:91], v[212:215]
    ds_read_b64_tr_b16 v[46:47], v11 offset:41984
    s_waitcnt lgkmcnt(10)
    v_mfma_f32_16x16x32_bf16 v[136:139], v[24:27], v[76:79], v[136:139]
    v_mfma_f32_16x16x32_bf16 v[140:143], v[24:27], v[80:83], v[140:143]
    v_mfma_f32_16x16x32_bf16 v[152:155], v[24:27], v[84:87], v[152:155]
    v_mfma_f32_16x16x32_bf16 v[156:159], v[24:27], v[88:91], v[156:159]
    s_waitcnt lgkmcnt(8)
    v_mfma_f32_16x16x32_bf16 v[200:203], v[28:31], v[76:79], v[200:203]
    v_mfma_f32_16x16x32_bf16 v[204:207], v[28:31], v[80:83], v[204:207]
    v_mfma_f32_16x16x32_bf16 v[216:219], v[28:31], v[84:87], v[216:219]
    v_mfma_f32_16x16x32_bf16 v[220:223], v[28:31], v[88:91], v[220:223]
    s_waitcnt lgkmcnt(6)
    v_mfma_f32_16x16x32_bf16 v[160:163], v[32:35], v[76:79], v[160:163]
    v_mfma_f32_16x16x32_bf16 v[164:167], v[32:35], v[80:83], v[164:167]
    s_waitcnt lgkmcnt(4)
    v_mfma_f32_16x16x32_bf16 v[224:227], v[36:39], v[76:79], v[224:227]
    v_mfma_f32_16x16x32_bf16 v[228:231], v[36:39], v[80:83], v[228:231]
    v_mfma_f32_16x16x32_bf16 v[176:179], v[32:35], v[84:87], v[176:179]
    v_mfma_f32_16x16x32_bf16 v[240:243], v[36:39], v[84:87], v[240:243]
    s_waitcnt lgkmcnt(0)
    s_waitcnt vmcnt(6)
    s_barrier
    ds_read_b128 v[48:51], v6 offset:0
    v_mfma_f32_16x16x32_bf16 v[180:183], v[32:35], v[88:91], v[180:183]
    ds_read_b64_tr_b16 v[16:17], v8 offset:0
    v_mfma_f32_16x16x32_bf16 v[244:247], v[36:39], v[88:91], v[244:247]
    ds_read_b64_tr_b16 v[18:19], v8 offset:1024
    s_add_u32 m0, s3, 32768
    s_nop 0
    buffer_load_dwordx4 v64, s[16:19], s52 offen lds
    buffer_load_dwordx4 v75, s[16:19], s52 offen offset:1024 lds
    v_mfma_f32_16x16x32_bf16 v[168:171], v[40:43], v[76:79], v[168:171]
    ds_read_b128 v[52:55], v6 offset:2048
    v_mfma_f32_16x16x32_bf16 v[172:175], v[40:43], v[80:83], v[172:175]
    ds_read_b64_tr_b16 v[20:21], v8 offset:8192
    s_add_u32 m0, s3, 34816
    s_nop 0
    buffer_load_dwordx4 v64, s[16:19], s53 offen lds
    buffer_load_dwordx4 v75, s[16:19], s53 offen offset:1024 lds
    v_mfma_f32_16x16x32_bf16 v[184:187], v[40:43], v[84:87], v[184:187]
    ds_read_b64_tr_b16 v[22:23], v8 offset:9216
    v_mfma_f32_16x16x32_bf16 v[188:191], v[40:43], v[88:91], v[188:191]
    ds_read_b128 v[56:59], v6 offset:4096
    s_add_u32 m0, s3, 65536
    s_nop 0
    buffer_load_dwordx4 v64, s[16:19], s54 offen lds
    buffer_load_dwordx4 v75, s[16:19], s54 offen offset:1024 lds
    v_mfma_f32_16x16x32_bf16 v[232:235], v[44:47], v[76:79], v[232:235]
    ds_read_b128 v[60:63], v6 offset:6144
    v_mfma_f32_16x16x32_bf16 v[236:239], v[44:47], v[80:83], v[236:239]
    ds_read_b64_tr_b16 v[24:25], v9 offset:0
    s_add_u32 m0, s3, 67584
    s_nop 0
    buffer_load_dwordx4 v64, s[16:19], s55 offen lds
    buffer_load_dwordx4 v75, s[16:19], s55 offen offset:1024 lds
    v_mfma_f32_16x16x32_bf16 v[248:251], v[44:47], v[84:87], v[248:251]
    ds_read_b64_tr_b16 v[26:27], v9 offset:1024
    v_mfma_f32_16x16x32_bf16 v[252:255], v[44:47], v[88:91], v[252:255]
    ds_read_b64_tr_b16 v[28:29], v9 offset:8192
    ds_read_b64_tr_b16 v[30:31], v9 offset:9216
    s_lshr_b32 s77, s101, 3
    s_lshl_b32 s77, s77, 2
    v_mov_b32 v14, 2
    v_lshlrev_b32 v5, 20, v0
    s_cmp_lg_u32 s70, 0
    s_cbranch_scc1 L_mf2
    buffer_store_dword v14, v5, s[92:95], s77 offen offset:128
L_mf2:
    s_waitcnt lgkmcnt(9)
    v_mfma_f32_16x16x32_bf16 v[128:131], v[16:19], v[48:51], v[128:131]
    ds_read_b64_tr_b16 v[32:33], v10 offset:0
    s_waitcnt lgkmcnt(9)
    v_mfma_f32_16x16x32_bf16 v[132:135], v[16:19], v[52:55], v[132:135]
    ds_read_b64_tr_b16 v[34:35], v10 offset:1024
    s_waitcnt lgkmcnt(8)
    v_mfma_f32_16x16x32_bf16 v[192:195], v[20:23], v[48:51], v[192:195]
    ds_read_b64_tr_b16 v[36:37], v10 offset:8192
    v_mfma_f32_16x16x32_bf16 v[196:199], v[20:23], v[52:55], v[196:199]
    ds_read_b64_tr_b16 v[38:39], v10 offset:9216
    s_waitcnt lgkmcnt(9)
    v_mfma_f32_16x16x32_bf16 v[144:147], v[16:19], v[56:59], v[144:147]
    ds_read_b64_tr_b16 v[40:41], v11 offset:0
    v_mfma_f32_16x16x32_bf16 v[208:211], v[20:23], v[56:59], v[208:211]
    ds_read_b64_tr_b16 v[42:43], v11 offset:1024
    s_waitcnt lgkmcnt(10)
    v_mfma_f32_16x16x32_bf16 v[148:151], v[16:19], v[60:63], v[148:151]
    ds_read_b64_tr_b16 v[44:45], v11 offset:8192
    v_mfma_f32_16x16x32_bf16 v[212:215], v[20:23], v[60:63], v[212:215]
    ds_read_b64_tr_b16 v[46:47], v11 offset:9216
    s_waitcnt lgkmcnt(10)
    v_mfma_f32_16x16x32_bf16 v[136:139], v[24:27], v[48:51], v[136:139]
    v_mfma_f32_16x16x32_bf16 v[140:143], v[24:27], v[52:55], v[140:143]
    v_mfma_f32_16x16x32_bf16 v[152:155], v[24:27], v[56:59], v[152:155]
    v_mfma_f32_16x16x32_bf16 v[156:159], v[24:27], v[60:63], v[156:159]
    s_waitcnt lgkmcnt(8)
    v_mfma_f32_16x16x32_bf16 v[200:203], v[28:31], v[48:51], v[200:203]
    v_mfma_f32_16x16x32_bf16 v[204:207], v[28:31], v[52:55], v[204:207]
    v_mfma_f32_16x16x32_bf16 v[216:219], v[28:31], v[56:59], v[216:219]
    v_mfma_f32_16x16x32_bf16 v[220:223], v[28:31], v[60:63], v[220:223]
    s_waitcnt lgkmcnt(6)
    v_mfma_f32_16x16x32_bf16 v[160:163], v[32:35], v[48:51], v[160:163]
    v_mfma_f32_16x16x32_bf16 v[164:167], v[32:35], v[52:55], v[164:167]
    s_waitcnt lgkmcnt(4)
    v_mfma_f32_16x16x32_bf16 v[224:227], v[36:39], v[48:51], v[224:227]
    v_mfma_f32_16x16x32_bf16 v[228:231], v[36:39], v[52:55], v[228:231]
    v_mfma_f32_16x16x32_bf16 v[176:179], v[32:35], v[56:59], v[176:179]
    v_mfma_f32_16x16x32_bf16 v[240:243], v[36:39], v[56:59], v[240:243]
    s_waitcnt lgkmcnt(0)
    s_waitcnt vmcnt(9)
    s_barrier
    ds_read_b128 v[76:79], v7 offset:0
    v_mfma_f32_16x16x32_bf16 v[180:183], v[32:35], v[60:63], v[180:183]
    ds_read_b64_tr_b16 v[16:17], v8 offset:16384
    v_mfma_f32_16x16x32_bf16 v[244:247], v[36:39], v[60:63], v[244:247]
    ds_read_b64_tr_b16 v[18:19], v8 offset:17408
    s_add_u32 m0, s3, 0
    s_nop 0
    buffer_load_dwordx4 v64, s[16:19], s56 offen lds
    buffer_load_dwordx4 v75, s[16:19], s56 offen offset:1024 lds
    v_mfma_f32_16x16x32_bf16 v[168:171], v[40:43], v[48:51], v[168:171]
    ds_read_b128 v[80:83], v7 offset:2048
    v_mfma_f32_16x16x32_bf16 v[172:175], v[40:43], v[52:55], v[172:175]
    ds_read_b64_tr_b16 v[20:21], v8 offset:24576
    s_add_u32 m0, s3, 2048
    s_nop 0
    buffer_load_dwordx4 v64, s[16:19], s57 offen lds
    buffer_load_dwordx4 v75, s[16:19], s57 offen offset:1024 lds
    v_mfma_f32_16x16x32_bf16 v[184:187], v[40:43], v[56:59], v[184:187]
    ds_read_b64_tr_b16 v[22:23], v8 offset:25600
    v_mfma_f32_16x16x32_bf16 v[188:191], v[40:43], v[60:63], v[188:191]
    ds_read_b128 v[84:87], v7 offset:4096
    v_mfma_f32_16x16x32_bf16 v[232:235], v[44:47], v[48:51], v[232:235]
    ds_read_b128 v[88:91], v7 offset:6144
    v_mfma_f32_16x16x32_bf16 v[236:239], v[44:47], v[52:55], v[236:239]
    ds_read_b64_tr_b16 v[24:25], v9 offset:16384
    v_mfma_f32_16x16x32_bf16 v[248:251], v[44:47], v[56:59], v[248:251]
    ds_read_b64_tr_b16 v[26:27], v9 offset:17408
    v_mfma_f32_16x16x32_bf16 v[252:255], v[44:47], v[60:63], v[252:255]
    ds_read_b64_tr_b16 v[28:29], v9 offset:24576
    ds_read_b64_tr_b16 v[30:31], v9 offset:25600
    s_waitcnt lgkmcnt(9)
    v_mfma_f32_16x16x32_bf16 v[128:131], v[16:19], v[76:79], v[128:131]
    ds_read_b64_tr_b16 v[32:33], v10 offset:16384
    s_waitcnt lgkmcnt(9)
    v_mfma_f32_16x16x32_bf16 v[132:135], v[16:19], v[80:83], v[132:135]
    ds_read_b64_tr_b16 v[34:35], v10 offset:17408
    s_waitcnt lgkmcnt(8)
    v_mfma_f32_16x16x32_bf16 v[192:195], v[20:23], v[76:79], v[192:195]
    ds_read_b64_tr_b16 v[36:37], v10 offset:24576
    v_mfma_f32_16x16x32_bf16 v[196:199], v[20:23], v[80:83], v[196:199]
    ds_read_b64_tr_b16 v[38:39], v10 offset:25600
    s_waitcnt lgkmcnt(9)
    v_mfma_f32_16x16x32_bf16 v[144:147], v[16:19], v[84:87], v[144:147]
    ds_read_b64_tr_b16 v[40:41], v11 offset:16384
    v_mfma_f32_16x16x32_bf16 v[208:211], v[20:23], v[84:87], v[208:211]
    ds_read_b64_tr_b16 v[42:43], v11 offset:17408
    s_waitcnt lgkmcnt(10)
    v_mfma_f32_16x16x32_bf16 v[148:151], v[16:19], v[88:91], v[148:151]
    ds_read_b64_tr_b16 v[44:45], v11 offset:24576
    v_mfma_f32_16x16x32_bf16 v[212:215], v[20:23], v[88:91], v[212:215]
    ds_read_b64_tr_b16 v[46:47], v11 offset:25600
    s_waitcnt lgkmcnt(10)
    v_mfma_f32_16x16x32_bf16 v[136:139], v[24:27], v[76:79], v[136:139]
    v_mfma_f32_16x16x32_bf16 v[140:143], v[24:27], v[80:83], v[140:143]
    v_mfma_f32_16x16x32_bf16 v[152:155], v[24:27], v[84:87], v[152:155]
    v_mfma_f32_16x16x32_bf16 v[156:159], v[24:27], v[88:91], v[156:159]
    s_waitcnt lgkmcnt(8)
    v_mfma_f32_16x16x32_bf16 v[200:203], v[28:31], v[76:79], v[200:203]
    v_mfma_f32_16x16x32_bf16 v[204:207], v[28:31], v[80:83], v[204:207]
    v_mfma_f32_16x16x32_bf16 v[216:219], v[28:31], v[84:87], v[216:219]
    v_mfma_f32_16x16x32_bf16 v[220:223], v[28:31], v[88:91], v[220:223]
    s_waitcnt lgkmcnt(6)
    v_mfma_f32_16x16x32_bf16 v[160:163], v[32:35], v[76:79], v[160:163]
    v_mfma_f32_16x16x32_bf16 v[164:167], v[32:35], v[80:83], v[164:167]
    s_waitcnt lgkmcnt(4)
    v_mfma_f32_16x16x32_bf16 v[224:227], v[36:39], v[76:79], v[224:227]
    v_mfma_f32_16x16x32_bf16 v[228:231], v[36:39], v[80:83], v[228:231]
    v_mfma_f32_16x16x32_bf16 v[176:179], v[32:35], v[84:87], v[176:179]
    v_mfma_f32_16x16x32_bf16 v[240:243], v[36:39], v[84:87], v[240:243]
    s_waitcnt lgkmcnt(0)
    s_barrier
    v_add_u32 v10, 0x10000, v66
    v_add_u32 v11, 0x10000, v67
    v_mfma_f32_16x16x32_bf16 v[180:183], v[32:35], v[88:91], v[180:183]
    v_mfma_f32_16x16x32_bf16 v[244:247], v[36:39], v[88:91], v[244:247]
    v_mfma_f32_16x16x32_bf16 v[168:171], v[40:43], v[76:79], v[168:171]
    v_mfma_f32_16x16x32_bf16 v[172:175], v[40:43], v[80:83], v[172:175]
    s_add_u32 m0, s3, 16384
    s_nop 0
    buffer_load_dwordx4 v64, s[16:19], s58 offen lds
    buffer_load_dwordx4 v75, s[16:19], s58 offen offset:1024 lds
    v_mfma_f32_16x16x32_bf16 v[184:187], v[40:43], v[84:87], v[184:187]
    v_mfma_f32_16x16x32_bf16 v[188:191], v[40:43], v[88:91], v[188:191]
    v_mfma_f32_16x16x32_bf16 v[232:235], v[44:47], v[76:79], v[232:235]
    v_mfma_f32_16x16x32_bf16 v[236:239], v[44:47], v[80:83], v[236:239]
    s_add_u32 s16, s16, 14336
    s_addc_u32 s17, s17, 0
    s_sub_u32 s18, s18, 14336
    s_add_u32 m0, s3, 18432
    s_nop 0
    buffer_load_dwordx4 v64, s[16:19], s52 offen lds
    buffer_load_dwordx4 v75, s[16:19], s52 offen offset:1024 lds
    v_mfma_f32_16x16x32_bf16 v[248:251], v[44:47], v[84:87], v[248:251]
    v_mfma_f32_16x16x32_bf16 v[252:255], v[44:47], v[88:91], v[252:255]
    v_mov_b32 v2, 0xc0135761
    v_mov_b32 v3, 0xc0135761
    v_mov_b32 v4, 0xbdd2d3e8
    v_mov_b32 v5, 0xbdd2d3e8
    v_mov_b32 v6, 1.0
    v_mov_b32 v7, 1.0
    v_pk_mul_f32 v[16:17], v[128:129], v[128:129]
    v_pk_mul_f32 v[18:19], v[130:131], v[130:131]
    v_pk_mul_f32 v[20:21], v[132:133], v[132:133]
    v_pk_mul_f32 v[22:23], v[134:135], v[134:135]
    v_pk_fma_f32 v[16:17], v[16:17], v[4:5], v[2:3]
    v_pk_fma_f32 v[18:19], v[18:19], v[4:5], v[2:3]
    v_pk_fma_f32 v[20:21], v[20:21], v[4:5], v[2:3]
    v_pk_fma_f32 v[22:23], v[22:23], v[4:5], v[2:3]
    v_pk_mul_f32 v[16:17], v[16:17], v[128:129]
    v_pk_mul_f32 v[18:19], v[18:19], v[130:131]
    v_pk_mul_f32 v[20:21], v[20:21], v[132:133]
    v_pk_mul_f32 v[22:23], v[22:23], v[134:135]
    v_exp_f32 v16, v16
    v_exp_f32 v17, v17
    v_exp_f32 v18, v18
    v_exp_f32 v19, v19
    s_add_u32 m0, s3, 49152
    s_nop 0
    buffer_load_dwordx4 v64, s[16:19], s53 offen lds
    buffer_load_dwordx4 v75, s[16:19], s53 offen offset:1024 lds
    v_exp_f32 v20, v20
    v_exp_f32 v21, v21
    v_exp_f32 v22, v22
    v_exp_f32 v23, v23
    v_pk_mul_f32 v[24:25], v[128:129], v[192:193]
    v_pk_mul_f32 v[26:27], v[130:131], v[194:195]
    v_pk_mul_f32 v[28:29], v[132:133], v[196:197]
    v_pk_mul_f32 v[30:31], v[134:135], v[198:199]
    v_pk_add_f32 v[16:17], v[16:17], v[6:7]
    v_pk_add_f32 v[18:19], v[18:19], v[6:7]
    v_pk_add_f32 v[20:21], v[20:21], v[6:7]
    v_pk_add_f32 v[22:23], v[22:23], v[6:7]
    v_rcp_f32 v16, v16
    v_rcp_f32 v17, v17
    v_rcp_f32 v18, v18
    v_rcp_f32 v19, v19
    s_add_u32 m0, s3, 51200
    s_nop 0
    buffer_load_dwordx4 v64, s[16:19], s54 offen lds
    buffer_load_dwordx4 v75, s[16:19], s54 offen offset:1024 lds
    v_rcp_f32 v20, v20
    v_rcp_f32 v21, v21
    v_rcp_f32 v22, v22
    v_rcp_f32 v23, v23
    v_pk_mul_f32 v[24:25], v[24:25], v[16:17]
    v_pk_mul_f32 v[26:27], v[26:27], v[18:19]
    v_pk_mul_f32 v[28:29], v[28:29], v[20:21]
    v_pk_mul_f32 v[30:31], v[30:31], v[22:23]
    v_cvt_pk_bf16_f32 v128, v24, v25
    v_cvt_pk_bf16_f32 v129, v26, v27
    v_cvt_pk_bf16_f32 v130, v28, v29
    v_cvt_pk_bf16_f32 v131, v30, v31
    s_nop 0
    v_permlane16_swap_b32 v128, v130
    v_permlane16_swap_b32 v129, v131
    s_add_u32 s77, s38, 0
    buffer_store_dwordx4 v[128:131], v65, s[12:15], s77 offen sc1
    v_pk_mul_f32 v[16:17], v[144:145], v[144:145]
    v_pk_mul_f32 v[18:19], v[146:147], v[146:147]
    v_pk_mul_f32 v[20:21], v[148:149], v[148:149]
    v_pk_mul_f32 v[22:23], v[150:151], v[150:151]
    v_pk_fma_f32 v[16:17], v[16:17], v[4:5], v[2:3]
    v_pk_fma_f32 v[18:19], v[18:19], v[4:5], v[2:3]
    v_pk_fma_f32 v[20:21], v[20:21], v[4:5], v[2:3]
    v_pk_fma_f32 v[22:23], v[22:23], v[4:5], v[2:3]
    v_pk_mul_f32 v[16:17], v[16:17], v[144:145]
    v_pk_mul_f32 v[18:19], v[18:19], v[146:147]
    v_pk_mul_f32 v[20:21], v[20:21], v[148:149]
    v_pk_mul_f32 v[22:23], v[22:23], v[150:151]
    v_exp_f32 v16, v16
    v_exp_f32 v17, v17
    v_exp_f32 v18, v18
    v_exp_f32 v19, v19
    v_exp_f32 v20, v20
    v_exp_f32 v21, v21
    v_exp_f32 v22, v22
    v_exp_f32 v23, v23
    v_pk_mul_f32 v[24:25], v[144:145], v[208:209]
    v_pk_mul_f32 v[26:27], v[146:147], v[210:211]
    v_pk_mul_f32 v[28:29], v[148:149], v[212:213]
    v_pk_mul_f32 v[30:31], v[150:151], v[214:215]
    v_pk_add_f32 v[16:17], v[16:17], v[6:7]
    v_pk_add_f32 v[18:19], v[18:19], v[6:7]
    v_pk_add_f32 v[20:21], v[20:21], v[6:7]
    v_pk_add_f32 v[22:23], v[22:23], v[6:7]
    v_rcp_f32 v16, v16
    v_rcp_f32 v17, v17
    v_rcp_f32 v18, v18
    v_rcp_f32 v19, v19
    v_rcp_f32 v20, v20
    v_rcp_f32 v21, v21
    v_rcp_f32 v22, v22
    v_rcp_f32 v23, v23
    v_pk_mul_f32 v[24:25], v[24:25], v[16:17]
    v_pk_mul_f32 v[26:27], v[26:27], v[18:19]
    v_pk_mul_f32 v[28:29], v[28:29], v[20:21]
    v_pk_mul_f32 v[30:31], v[30:31], v[22:23]
    v_cvt_pk_bf16_f32 v144, v24, v25
    v_cvt_pk_bf16_f32 v145, v26, v27
    v_cvt_pk_bf16_f32 v146, v28, v29
    v_cvt_pk_bf16_f32 v147, v30, v31
    s_nop 0
    v_permlane16_swap_b32 v144, v146
    v_permlane16_swap_b32 v145, v147
    s_add_u32 s77, s38, 114688
    buffer_store_dwordx4 v[144:147], v65, s[12:15], s77 offen sc1
    v_pk_mul_f32 v[16:17], v[136:137], v[136:137]
    v_pk_mul_f32 v[18:19], v[138:139], v[138:139]
    v_pk_mul_f32 v[20:21], v[140:141], v[140:141]
    v_pk_mul_f32 v[22:23], v[142:143], v[142:143]
    v_pk_fma_f32 v[16:17], v[16:17], v[4:5], v[2:3]
    v_pk_fma_f32 v[18:19], v[18:19], v[4:5], v[2:3]
    v_pk_fma_f32 v[20:21], v[20:21], v[4:5], v[2:3]
    v_pk_fma_f32 v[22:23], v[22:23], v[4:5], v[2:3]
    v_pk_mul_f32 v[16:17], v[16:17], v[136:137]
    v_pk_mul_f32 v[18:19], v[18:19], v[138:139]
    v_pk_mul_f32 v[20:21], v[20:21], v[140:141]
    v_pk_mul_f32 v[22:23], v[22:23], v[142:143]
    v_exp_f32 v16, v16
    v_exp_f32 v17, v17
    v_exp_f32 v18, v18
    v_exp_f32 v19, v19
    v_exp_f32 v20, v20
    v_exp_f32 v21, v21
    v_exp_f32 v22, v22
    v_exp_f32 v23, v23
    v_pk_mul_f32 v[24:25], v[136:137], v[200:201]
    v_pk_mul_f32 v[26:27], v[138:139], v[202:203]
    v_pk_mul_f32 v[28:29], v[140:141], v[204:205]
    v_pk_mul_f32 v[30:31], v[142:143], v[206:207]
    v_pk_add_f32 v[16:17], v[16:17], v[6:7]
    v_pk_add_f32 v[18:19], v[18:19], v[6:7]
    v_pk_add_f32 v[20:21], v[20:21], v[6:7]
    v_pk_add_f32 v[22:23], v[22:23], v[6:7]
    v_rcp_f32 v16, v16
    v_rcp_f32 v17, v17
    v_rcp_f32 v18, v18
    v_rcp_f32 v19, v19
    v_rcp_f32 v20, v20
    v_rcp_f32 v21, v21
    v_rcp_f32 v22, v22
    v_rcp_f32 v23, v23
    v_pk_mul_f32 v[24:25], v[24:25], v[16:17]
    v_pk_mul_f32 v[26:27], v[26:27], v[18:19]
    v_pk_mul_f32 v[28:29], v[28:29], v[20:21]
    v_pk_mul_f32 v[30:31], v[30:31], v[22:23]
    v_cvt_pk_bf16_f32 v136, v24, v25
    v_cvt_pk_bf16_f32 v137, v26, v27
    v_cvt_pk_bf16_f32 v138, v28, v29
    v_cvt_pk_bf16_f32 v139, v30, v31
    s_nop 0
    v_permlane16_swap_b32 v136, v138
    v_permlane16_swap_b32 v137, v139
    s_add_u32 s77, s38, 28672
    buffer_store_dwordx4 v[136:139], v65, s[12:15], s77 offen sc1
    v_pk_mul_f32 v[16:17], v[152:153], v[152:153]
    v_pk_mul_f32 v[18:19], v[154:155], v[154:155]
    v_pk_mul_f32 v[20:21], v[156:157], v[156:157]
    v_pk_mul_f32 v[22:23], v[158:159], v[158:159]
    v_pk_fma_f32 v[16:17], v[16:17], v[4:5], v[2:3]
    v_pk_fma_f32 v[18:19], v[18:19], v[4:5], v[2:3]
    v_pk_fma_f32 v[20:21], v[20:21], v[4:5], v[2:3]
    v_pk_fma_f32 v[22:23], v[22:23], v[4:5], v[2:3]
    v_pk_mul_f32 v[16:17], v[16:17], v[152:153]
    v_pk_mul_f32 v[18:19], v[18:19], v[154:155]
    v_pk_mul_f32 v[20:21], v[20:21], v[156:157]
    v_pk_mul_f32 v[22:23], v[22:23], v[158:159]
    v_exp_f32 v16, v16
    v_exp_f32 v17, v17
    v_exp_f32 v18, v18
    v_exp_f32 v19, v19
    v_exp_f32 v20, v20
    v_exp_f32 v21, v21
    v_exp_f32 v22, v22
    v_exp_f32 v23, v23
    v_pk_mul_f32 v[24:25], v[152:153], v[216:217]
    v_pk_mul_f32 v[26:27], v[154:155], v[218:219]
    v_pk_mul_f32 v[28:29], v[156:157], v[220:221]
    v_pk_mul_f32 v[30:31], v[158:159], v[222:223]
    v_pk_add_f32 v[16:17], v[16:17], v[6:7]
    v_pk_add_f32 v[18:19], v[18:19], v[6:7]
    v_pk_add_f32 v[20:21], v[20:21], v[6:7]
    v_pk_add_f32 v[22:23], v[22:23], v[6:7]
    v_rcp_f32 v16, v16
    v_rcp_f32 v17, v17
    v_rcp_f32 v18, v18
    v_rcp_f32 v19, v19
    v_rcp_f32 v20, v20
    v_rcp_f32 v21, v21
    v_rcp_f32 v22, v22
    v_rcp_f32 v23, v23
    v_pk_mul_f32 v[24:25], v[24:25], v[16:17]
    v_pk_mul_f32 v[26:27], v[26:27], v[18:19]
    v_pk_mul_f32 v[28:29], v[28:29], v[20:21]
    v_pk_mul_f32 v[30:31], v[30:31], v[22:23]
    v_cvt_pk_bf16_f32 v152, v24, v25
    v_cvt_pk_bf16_f32 v153, v26, v27
    v_cvt_pk_bf16_f32 v154, v28, v29
    v_cvt_pk_bf16_f32 v155, v30, v31
    s_nop 0
    v_permlane16_swap_b32 v152, v154
    v_permlane16_swap_b32 v153, v155
    s_add_u32 s77, s38, 143360
    buffer_store_dwordx4 v[152:155], v65, s[12:15], s77 offen sc1
    v_pk_mul_f32 v[16:17], v[160:161], v[160:161]
    v_pk_mul_f32 v[18:19], v[162:163], v[162:163]
    v_pk_mul_f32 v[20:21], v[164:165], v[164:165]
    v_pk_mul_f32 v[22:23], v[166:167], v[166:167]
    v_pk_fma_f32 v[16:17], v[16:17], v[4:5], v[2:3]
    v_pk_fma_f32 v[18:19], v[18:19], v[4:5], v[2:3]
    v_pk_fma_f32 v[20:21], v[20:21], v[4:5], v[2:3]
    v_pk_fma_f32 v[22:23], v[22:23], v[4:5], v[2:3]
    v_pk_mul_f32 v[16:17], v[16:17], v[160:161]
    v_pk_mul_f32 v[18:19], v[18:19], v[162:163]
    v_pk_mul_f32 v[20:21], v[20:21], v[164:165]
    v_pk_mul_f32 v[22:23], v[22:23], v[166:167]
    v_exp_f32 v16, v16
    v_exp_f32 v17, v17
    v_exp_f32 v18, v18
    v_exp_f32 v19, v19
    v_exp_f32 v20, v20
    v_exp_f32 v21, v21
    v_exp_f32 v22, v22
    v_exp_f32 v23, v23
    v_pk_mul_f32 v[24:25], v[160:161], v[224:225]
    v_pk_mul_f32 v[26:27], v[162:163], v[226:227]
    v_pk_mul_f32 v[28:29], v[164:165], v[228:229]
    v_pk_mul_f32 v[30:31], v[166:167], v[230:231]
    v_pk_add_f32 v[16:17], v[16:17], v[6:7]
    v_pk_add_f32 v[18:19], v[18:19], v[6:7]
    v_pk_add_f32 v[20:21], v[20:21], v[6:7]
    v_pk_add_f32 v[22:23], v[22:23], v[6:7]
    v_rcp_f32 v16, v16
    v_rcp_f32 v17, v17
    v_rcp_f32 v18, v18
    v_rcp_f32 v19, v19
    v_rcp_f32 v20, v20
    v_rcp_f32 v21, v21
    v_rcp_f32 v22, v22
    v_rcp_f32 v23, v23
    v_pk_mul_f32 v[24:25], v[24:25], v[16:17]
    v_pk_mul_f32 v[26:27], v[26:27], v[18:19]
    v_pk_mul_f32 v[28:29], v[28:29], v[20:21]
    v_pk_mul_f32 v[30:31], v[30:31], v[22:23]
    v_cvt_pk_bf16_f32 v160, v24, v25
    v_cvt_pk_bf16_f32 v161, v26, v27
    v_cvt_pk_bf16_f32 v162, v28, v29
    v_cvt_pk_bf16_f32 v163, v30, v31
    s_nop 0
    v_permlane16_swap_b32 v160, v162
    v_permlane16_swap_b32 v161, v163
    s_add_u32 s77, s38, 57344
    buffer_store_dwordx4 v[160:163], v65, s[12:15], s77 offen sc1
    s_waitcnt vmcnt(3)
    v_readfirstlane_b32 s87, v13
    s_nop 0
    s_cmp_lg_u32 s87, 0
    s_cbranch_scc1 L_gnd3
    s_mov_b32 s78, 0
L_gn3:
    buffer_load_dword v13, v12, s[92:95], 0 offen sc1
    s_waitcnt vmcnt(0)
    v_readfirstlane_b32 s87, v13
    s_add_u32 s78, s78, 1
    s_cmp_lg_u32 s87, 0
    s_cbranch_scc1 L_gnd3
    s_sleep 8
    s_cmp_lt_u32 s78, 0x2000
    s_cbranch_scc1 L_gn3
L_gnd3:
    s_nop 0
    v_mov_b32 v192, 0
    v_mov_b32 v193, 0
    v_mov_b32 v194, 0
    v_mov_b32 v195, 0
    v_lshlrev_b32 v13, 4, v0
    v_and_b32 v12, 56, v0
    v_lshl_add_u32 v13, v12, 20, v13
    v_mov_b32 v192, s87
    buffer_store_dwordx4 v[192:195], v13, s[88:91], s100 offen sc1
    v_pk_mul_f32 v[16:17], v[176:177], v[176:177]
    v_pk_mul_f32 v[18:19], v[178:179], v[178:179]
    v_pk_mul_f32 v[20:21], v[180:181], v[180:181]
    v_pk_mul_f32 v[22:23], v[182:183], v[182:183]
    v_pk_fma_f32 v[16:17], v[16:17], v[4:5], v[2:3]
    v_pk_fma_f32 v[18:19], v[18:19], v[4:5], v[2:3]
    v_pk_fma_f32 v[20:21], v[20:21], v[4:5], v[2:3]
    v_pk_fma_f32 v[22:23], v[22:23], v[4:5], v[2:3]
    v_pk_mul_f32 v[16:17], v[16:17], v[176:177]
    v_pk_mul_f32 v[18:19], v[18:19], v[178:179]
    v_pk_mul_f32 v[20:21], v[20:21], v[180:181]
    v_pk_mul_f32 v[22:23], v[22:23], v[182:183]
    v_exp_f32 v16, v16
    v_exp_f32 v17, v17
    v_exp_f32 v18, v18
    v_exp_f32 v19, v19
    v_exp_f32 v20, v20
    v_exp_f32 v21, v21
    v_exp_f32 v22, v22
    v_exp_f32 v23, v23
    v_pk_mul_f32 v[24:25], v[176:177], v[240:241]
    v_pk_mul_f32 v[26:27], v[178:179], v[242:243]
    v_pk_mul_f32 v[28:29], v[180:181], v[244:245]
    v_pk_mul_f32 v[30:31], v[182:183], v[246:247]
    v_pk_add_f32 v[16:17], v[16:17], v[6:7]
    v_pk_add_f32 v[18:19], v[18:19], v[6:7]
    v_pk_add_f32 v[20:21], v[20:21], v[6:7]
    v_pk_add_f32 v[22:23], v[22:23], v[6:7]
    v_rcp_f32 v16, v16
    v_rcp_f32 v17, v17
    v_rcp_f32 v18, v18
    v_rcp_f32 v19, v19
    v_rcp_f32 v20, v20
    v_rcp_f32 v21, v21
    v_rcp_f32 v22, v22
    v_rcp_f32 v23, v23
    v_pk_mul_f32 v[24:25], v[24:25], v[16:17]
    v_pk_mul_f32 v[26:27], v[26:27], v[18:19]
    v_pk_mul_f32 v[28:29], v[28:29], v[20:21]
    v_pk_mul_f32 v[30:31], v[30:31], v[22:23]
    v_cvt_pk_bf16_f32 v176, v24, v25
    v_cvt_pk_bf16_f32 v177, v26, v27
    v_cvt_pk_bf16_f32 v178, v28, v29
    v_cvt_pk_bf16_f32 v179, v30, v31
    s_nop 0
    v_permlane16_swap_b32 v176, v178
    v_permlane16_swap_b32 v177, v179
    s_add_u32 s77, s38, 172032
    buffer_store_dwordx4 v[176:179], v65, s[12:15], s77 offen sc1
    v_pk_mul_f32 v[16:17], v[168:169], v[168:169]
    v_pk_mul_f32 v[18:19], v[170:171], v[170:171]
    v_pk_mul_f32 v[20:21], v[172:173], v[172:173]
    v_pk_mul_f32 v[22:23], v[174:175], v[174:175]
    v_pk_fma_f32 v[16:17], v[16:17], v[4:5], v[2:3]
    v_pk_fma_f32 v[18:19], v[18:19], v[4:5], v[2:3]
    v_pk_fma_f32 v[20:21], v[20:21], v[4:5], v[2:3]
    v_pk_fma_f32 v[22:23], v[22:23], v[4:5], v[2:3]
    v_pk_mul_f32 v[16:17], v[16:17], v[168:169]
    v_pk_mul_f32 v[18:19], v[18:19], v[170:171]
    v_pk_mul_f32 v[20:21], v[20:21], v[172:173]
    v_pk_mul_f32 v[22:23], v[22:23], v[174:175]
    v_exp_f32 v16, v16
    v_exp_f32 v17, v17
    v_exp_f32 v18, v18
    v_exp_f32 v19, v19
    v_exp_f32 v20, v20
    v_exp_f32 v21, v21
    v_exp_f32 v22, v22
    v_exp_f32 v23, v23
    v_pk_mul_f32 v[24:25], v[168:169], v[232:233]
    v_pk_mul_f32 v[26:27], v[170:171], v[234:235]
    v_pk_mul_f32 v[28:29], v[172:173], v[236:237]
    v_pk_mul_f32 v[30:31], v[174:175], v[238:239]
    v_pk_add_f32 v[16:17], v[16:17], v[6:7]
    v_pk_add_f32 v[18:19], v[18:19], v[6:7]
    v_pk_add_f32 v[20:21], v[20:21], v[6:7]
    v_pk_add_f32 v[22:23], v[22:23], v[6:7]
    v_rcp_f32 v16, v16
    v_rcp_f32 v17, v17
    v_rcp_f32 v18, v18
    v_rcp_f32 v19, v19
    v_rcp_f32 v20, v20
    v_rcp_f32 v21, v21
    v_rcp_f32 v22, v22
    v_rcp_f32 v23, v23
    v_pk_mul_f32 v[24:25], v[24:25], v[16:17]
    v_pk_mul_f32 v[26:27], v[26:27], v[18:19]
    v_pk_mul_f32 v[28:29], v[28:29], v[20:21]
    v_pk_mul_f32 v[30:31], v[30:31], v[22:23]
    v_cvt_pk_bf16_f32 v168, v24, v25
    v_cvt_pk_bf16_f32 v169, v26, v27
    v_cvt_pk_bf16_f32 v170, v28, v29
    v_cvt_pk_bf16_f32 v171, v30, v31
    s_nop 0
    v_permlane16_swap_b32 v168, v170
    v_permlane16_swap_b32 v169, v171
    s_add_u32 s77, s38, 86016
    buffer_store_dwordx4 v[168:171], v65, s[12:15], s77 offen sc1
    s_waitcnt vmcnt(4)
    v_mov_b32 v193, s87
    buffer_store_dwordx4 v[192:195], v13, s[88:91], s100 offen sc1
    v_pk_mul_f32 v[16:17], v[184:185], v[184:185]
    v_pk_mul_f32 v[18:19], v[186:187], v[186:187]
    v_pk_mul_f32 v[20:21], v[188:189], v[188:189]
    v_pk_mul_f32 v[22:23], v[190:191], v[190:191]
    v_pk_fma_f32 v[16:17], v[16:17], v[4:5], v[2:3]
    v_pk_fma_f32 v[18:19], v[18:19], v[4:5], v[2:3]
    v_pk_fma_f32 v[20:21], v[20:21], v[4:5], v[2:3]
    v_pk_fma_f32 v[22:23], v[22:23], v[4:5], v[2:3]
    v_pk_mul_f32 v[16:17], v[16:17], v[184:185]
    v_pk_mul_f32 v[18:19], v[18:19], v[186:187]
    v_pk_mul_f32 v[20:21], v[20:21], v[188:189]
    v_pk_mul_f32 v[22:23], v[22:23], v[190:191]
    v_exp_f32 v16, v16
    v_exp_f32 v17, v17
    v_exp_f32 v18, v18
    v_exp_f32 v19, v19
    v_exp_f32 v20, v20
    v_exp_f32 v21, v21
    v_exp_f32 v22, v22
    v_exp_f32 v23, v23
    v_pk_mul_f32 v[24:25], v[184:185], v[248:249]
    v_pk_mul_f32 v[26:27], v[186:187], v[250:251]
    v_pk_mul_f32 v[28:29], v[188:189], v[252:253]
    v_pk_mul_f32 v[30:31], v[190:191], v[254:255]
    v_pk_add_f32 v[16:17], v[16:17], v[6:7]
    v_pk_add_f32 v[18:19], v[18:19], v[6:7]
    v_pk_add_f32 v[20:21], v[20:21], v[6:7]
    v_pk_add_f32 v[22:23], v[22:23], v[6:7]
    v_rcp_f32 v16, v16
    v_rcp_f32 v17, v17
    v_rcp_f32 v18, v18
    v_rcp_f32 v19, v19
    v_rcp_f32 v20, v20
    v_rcp_f32 v21, v21
    v_rcp_f32 v22, v22
    v_rcp_f32 v23, v23
    v_pk_mul_f32 v[24:25], v[24:25], v[16:17]
    v_pk_mul_f32 v[26:27], v[26:27], v[18:19]
    v_pk_mul_f32 v[28:29], v[28:29], v[20:21]
    v_pk_mul_f32 v[30:31], v[30:31], v[22:23]
    v_cvt_pk_bf16_f32 v184, v24, v25
    v_cvt_pk_bf16_f32 v185, v26, v27
    v_cvt_pk_bf16_f32 v186, v28, v29
    v_cvt_pk_bf16_f32 v187, v30, v31
    s_nop 0
    v_permlane16_swap_b32 v184, v186
    v_permlane16_swap_b32 v185, v187
    s_add_u32 s77, s38, 200704
    buffer_store_dwordx4 v[184:187], v65, s[12:15], s77 offen sc1
    ds_read_b64_tr_b16 v[32:33], v66 offset:32768
    ds_read_b64_tr_b16 v[34:35], v66 offset:33280
    ds_read_b64_tr_b16 v[36:37], v67 offset:32768
    ds_read_b64_tr_b16 v[38:39], v67 offset:33280
    ds_read_b64_tr_b16 v[40:41], v66 offset:34816
    ds_read_b64_tr_b16 v[42:43], v66 offset:35328
    ds_read_b64_tr_b16 v[44:45], v67 offset:34816
    ds_read_b64_tr_b16 v[46:47], v67 offset:35328
    ds_read_b64_tr_b16 v[48:49], v10 offset:0
    ds_read_b64_tr_b16 v[50:51], v10 offset:512
    ds_read_b64_tr_b16 v[52:53], v11 offset:0
    ds_read_b64_tr_b16 v[54:55], v11 offset:512
    s_waitcnt lgkmcnt(4)
    ds_read_b64_tr_b16 v[56:57], v10 offset:2048
    ds_read_b64_tr_b16 v[58:59], v10 offset:2560
    ds_read_b64_tr_b16 v[60:61], v11 offset:2048
    ds_read_b64_tr_b16 v[62:63], v11 offset:2560
    ds_read_b64_tr_b16 v[76:77], v66 offset:0
    ds_read_b64_tr_b16 v[78:79], v66 offset:512
    ds_read_b64_tr_b16 v[80:81], v67 offset:0
    ds_read_b64_tr_b16 v[82:83], v67 offset:512
    ds_read_b64_tr_b16 v[84:85], v66 offset:2048
    ds_read_b64_tr_b16 v[86:87], v66 offset:2560
    ds_read_b64_tr_b16 v[88:89], v67 offset:2048
    ds_read_b64_tr_b16 v[90:91], v67 offset:2560
    s_waitcnt lgkmcnt(4)
    ds_read_b64_tr_b16 v[92:93], v66 offset:16384
    ds_read_b64_tr_b16 v[94:95], v66 offset:16896
    ds_read_b64_tr_b16 v[96:97], v67 offset:16384
    ds_read_b64_tr_b16 v[98:99], v67 offset:16896
    ds_read_b64_tr_b16 v[100:101], v66 offset:18432
    ds_read_b64_tr_b16 v[102:103], v66 offset:18944
    ds_read_b64_tr_b16 v[104:105], v67 offset:18432
    ds_read_b64_tr_b16 v[106:107], v67 offset:18944
    ds_read_b64_tr_b16 v[108:109], v66 offset:49152
    ds_read_b64_tr_b16 v[110:111], v66 offset:49664
    ds_read_b64_tr_b16 v[112:113], v67 offset:49152
    ds_read_b64_tr_b16 v[114:115], v67 offset:49664
    s_waitcnt lgkmcnt(4)
    ds_read_b64_tr_b16 v[116:117], v66 offset:51200
    ds_read_b64_tr_b16 v[118:119], v66 offset:51712
    ds_read_b64_tr_b16 v[120:121], v67 offset:51200
    ds_read_b64_tr_b16 v[122:123], v67 offset:51712
    s_waitcnt lgkmcnt(0)
    s_add_u32 m0, s3, 49152
    s_nop 0
    buffer_load_dwordx4 v64, s[16:19], s55 offen lds
    buffer_load_dwordx4 v75, s[16:19], s55 offen offset:1024 lds
    s_add_u32 m0, s3, 51200
    s_nop 0
    buffer_load_dwordx4 v64, s[16:19], s56 offen lds
    buffer_load_dwordx4 v75, s[16:19], s56 offen offset:1024 lds
    s_add_u32 m0, s3, 32768
    s_nop 0
    buffer_load_dwordx4 v64, s[16:19], s57 offen lds
    buffer_load_dwordx4 v75, s[16:19], s57 offen offset:1024 lds
    s_mov_b32 s78, 0
L_sq4:
    s_load_dword s71, s[60:61], 0 glc
    s_load_dword s72, s[60:61], 128 glc
    s_load_dword s73, s[60:61], 256 glc
    s_load_dword s74, s[60:61], 384 glc
    s_load_dword s75, s[60:61], 512 glc
    s_load_dword s76, s[60:61], 640 glc
    s_load_dword s79, s[60:61], 768 glc
L_sqc4:
    s_add_u32 s78, s78, 1
    s_waitcnt lgkmcnt(0)
    s_xor_b32 s71, s71, s87
    s_xor_b32 s72, s72, s87
    s_or_b32 s71, s71, s72
    s_xor_b32 s73, s73, s87
    s_or_b32 s71, s71, s73
    s_xor_b32 s74, s74, s87
    s_or_b32 s71, s71, s74
    s_xor_b32 s75, s75, s87
    s_or_b32 s71, s71, s75
    s_xor_b32 s76, s76, s87
    s_or_b32 s71, s71, s76
    s_xor_b32 s79, s79, s87
    s_or_b32 s71, s71, s79
    s_cbranch_scc0 L_sqd4
    s_sleep 2
    s_cmp_lt_u32 s78, 0x2000
    s_cbranch_scc1 L_sq4
L_sqd4:
    s_load_dword s71, s[60:61], 4 glc
    s_load_dword s72, s[60:61], 132 glc
    s_load_dword s73, s[60:61], 260 glc
    s_load_dword s74, s[60:61], 388 glc
    s_load_dword s75, s[60:61], 516 glc
    s_load_dword s76, s[60:61], 644 glc
    s_load_dword s79, s[60:61], 772 glc
    buffer_load_dwordx4 v[128:131], v70, s[96:99], s44 offen sc1
    buffer_load_dwordx4 v[132:135], v74, s[96:99], s44 offen sc1
    buffer_load_dwordx4 v[136:139], v70, s[96:99], s45 offen sc1
    buffer_load_dwordx4 v[140:143], v74, s[96:99], s45 offen sc1
    buffer_load_dwordx4 v[144:147], v70, s[96:99], s46 offen sc1
    buffer_load_dwordx4 v[148:151], v74, s[96:99], s46 offen sc1
    buffer_load_dwordx4 v[152:155], v70, s[96:99], s47 offen sc1
    buffer_load_dwordx4 v[156:159], v74, s[96:99], s47 offen sc1
    buffer_load_dwordx4 v[160:163], v70, s[96:99], s48 offen sc1
    buffer_load_dwordx4 v[164:167], v74, s[96:99], s48 offen sc1
    buffer_load_dwordx4 v[168:171], v70, s[96:99], s49 offen sc1
    buffer_load_dwordx4 v[172:175], v74, s[96:99], s49 offen sc1
    buffer_load_dwordx4 v[176:179], v70, s[96:99], s50 offen sc1
    buffer_load_dwordx4 v[180:183], v74, s[96:99], s50 offen sc1
    s_add_u32 m0, s3, 34816
    s_nop 0
    buffer_load_dwordx4 v64, s[16:19], s58 offen lds
    buffer_load_dwordx4 v75, s[16:19], s58 offen offset:1024 lds
    s_add_u32 s16, s16, 14336
    s_addc_u32 s17, s17, 0
    s_sub_u32 s18, s18, 14336
    s_add_u32 m0, s3, 65536
    s_nop 0
    buffer_load_dwordx4 v64, s[16:19], s52 offen lds
    buffer_load_dwordx4 v75, s[16:19], s52 offen offset:1024 lds
    s_add_u32 m0, s3, 67584
    s_nop 0
    buffer_load_dwordx4 v64, s[16:19], s53 offen lds
    buffer_load_dwordx4 v75, s[16:19], s53 offen offset:1024 lds
    s_waitcnt vmcnt(29)
    v_mov_b32 v194, s87
    buffer_store_dwordx4 v[192:195], v13, s[88:91], s100 offen sc1
    s_waitcnt vmcnt(27)
    s_nop 0
    v_mov_b32 v195, s87
    buffer_store_dwordx4 v[192:195], v13, s[88:91], s100 offen sc1
    s_waitcnt vmcnt(20) lgkmcnt(0)
    s_nop 0
    v_mfma_f32_32x32x16_bf16 v[192:207], v[32:35], v[128:131], 0
    s_mov_b32 s78, 0
    s_branch L_sqc5
L_sq5:
    s_load_dword s71, s[60:61], 4 glc
    s_load_dword s72, s[60:61], 132 glc
    s_load_dword s73, s[60:61], 260 glc
    s_load_dword s74, s[60:61], 388 glc
    s_load_dword s75, s[60:61], 516 glc
    s_load_dword s76, s[60:61], 644 glc
    s_load_dword s79, s[60:61], 772 glc
L_sqc5:
    s_add_u32 s78, s78, 1
    s_waitcnt lgkmcnt(0)
    s_xor_b32 s71, s71, s87
    s_xor_b32 s72, s72, s87
    s_or_b32 s71, s71, s72
    s_xor_b32 s73, s73, s87
    s_or_b32 s71, s71, s73
    s_xor_b32 s74, s74, s87
    s_or_b32 s71, s71, s74
    s_xor_b32 s75, s75, s87
    s_or_b32 s71, s71, s75
    s_xor_b32 s76, s76, s87
    s_or_b32 s71, s71, s76
    s_xor_b32 s79, s79, s87
    s_or_b32 s71, s71, s79
    s_cbranch_scc0 L_sqd5
    s_sleep 2
    s_cmp_lt_u32 s78, 0x2000
    s_cbranch_scc1 L_sq5
L_sqd5:
    s_add_u32 s96, s96, 28672
    s_addc_u32 s97, s97, 0
    s_sub_u32 s98, s98, 28672
    buffer_load_dwordx4 v[184:187], v70, s[96:99], s44 offen sc1
    buffer_load_dwordx4 v[188:191], v74, s[96:99], s44 offen sc1
    v_mfma_f32_32x32x16_bf16 v[208:223], v[32:35], v[132:135], 0
    v_mfma_f32_32x32x16_bf16 v[224:239], v[36:39], v[128:131], 0
    s_add_u32 m0, s3, 0
    s_nop 0
    buffer_load_dwordx4 v64, s[16:19], s54 offen lds
    buffer_load_dwordx4 v75, s[16:19], s54 offen offset:1024 lds
    v_mfma_f32_32x32x16_bf16 v[240:255], v[36:39], v[132:135], 0
    buffer_load_dwordx4 v[128:131], v70, s[96:99], s45 offen sc1
    buffer_load_dwordx4 v[132:135], v74, s[96:99], s45 offen sc1
    s_waitcnt vmcnt(24)
    v_mfma_f32_32x32x16_bf16 v[192:207], v[40:43], v[136:139], v[192:207]
    v_mfma_f32_32x32x16_bf16 v[208:223], v[40:43], v[140:143], v[208:223]
    v_mfma_f32_32x32x16_bf16 v[224:239], v[44:47], v[136:139], v[224:239]
    s_add_u32 m0, s3, 2048
    s_nop 0
    buffer_load_dwordx4 v64, s[16:19], s55 offen lds
    buffer_load_dwordx4 v75, s[16:19], s55 offen offset:1024 lds
    v_mfma_f32_32x32x16_bf16 v[240:255], v[44:47], v[140:143], v[240:255]
    buffer_load_dwordx4 v[136:139], v70, s[96:99], s46 offen sc1
    buffer_load_dwordx4 v[140:143], v74, s[96:99], s46 offen sc1
    s_waitcnt vmcnt(26)
    v_mfma_f32_32x32x16_bf16 v[192:207], v[48:51], v[144:147], v[192:207]
    v_mfma_f32_32x32x16_bf16 v[208:223], v[48:51], v[148:151], v[208:223]
    v_mfma_f32_32x32x16_bf16 v[224:239], v[52:55], v[144:147], v[224:239]
    s_add_u32 m0, s3, 16384
    s_nop 0
    buffer_load_dwordx4 v64, s[16:19], s56 offen lds
    buffer_load_dwordx4 v75, s[16:19], s56 offen offset:1024 lds
    v_mfma_f32_32x32x16_bf16 v[240:255], v[52:55], v[148:151], v[240:255]
    buffer_load_dwordx4 v[144:147], v70, s[96:99], s47 offen sc1
    buffer_load_dwordx4 v[148:151], v74, s[96:99], s47 offen sc1
    s_waitcnt vmcnt(28)
    v_mfma_f32_32x32x16_bf16 v[192:207], v[56:59], v[152:155], v[192:207]
    v_mfma_f32_32x32x16_bf16 v[208:223], v[56:59], v[156:159], v[208:223]
    v_mfma_f32_32x32x16_bf16 v[224:239], v[60:63], v[152:155], v[224:239]
    s_add_u32 m0, s3, 18432
    s_nop 0
    buffer_load_dwordx4 v64, s[16:19], s57 offen lds
    buffer_load_dwordx4 v75, s[16:19], s57 offen offset:1024 lds
    v_mfma_f32_32x32x16_bf16 v[240:255], v[60:63], v[156:159], v[240:255]
    buffer_load_dwordx4 v[152:155], v70, s[96:99], s48 offen sc1
    buffer_load_dwordx4 v[156:159], v74, s[96:99], s48 offen sc1
    s_waitcnt vmcnt(30)
    v_mfma_f32_32x32x16_bf16 v[192:207], v[76:79], v[160:163], v[192:207]
    v_mfma_f32_32x32x16_bf16 v[208:223], v[76:79], v[164:167], v[208:223]
    v_mfma_f32_32x32x16_bf16 v[224:239], v[80:83], v[160:163], v[224:239]
    v_mfma_f32_32x32x16_bf16 v[240:255], v[80:83], v[164:167], v[240:255]
    buffer_load_dwordx4 v[160:163], v70, s[96:99], s49 offen sc1
    buffer_load_dwordx4 v[164:167], v74, s[96:99], s49 offen sc1
    s_load_dword s71, s[60:61], 8 glc
    s_load_dword s72, s[60:61], 136 glc
    s_load_dword s73, s[60:61], 264 glc
    s_load_dword s74, s[60:61], 392 glc
    s_load_dword s75, s[60:61], 520 glc
    s_load_dword s76, s[60:61], 648 glc
    s_load_dword s79, s[60:61], 776 glc
    s_waitcnt vmcnt(30)
    v_mfma_f32_32x32x16_bf16 v[192:207], v[84:87], v[168:171], v[192:207]
    v_mfma_f32_32x32x16_bf16 v[208:223], v[84:87], v[172:175], v[208:223]
    v_mfma_f32_32x32x16_bf16 v[224:239], v[88:91], v[168:171], v[224:239]
    v_mfma_f32_32x32x16_bf16 v[240:255], v[88:91], v[172:175], v[240:255]
    buffer_load_dwordx4 v[168:171], v70, s[96:99], s50 offen sc1
    buffer_load_dwordx4 v[172:175], v74, s[96:99], s50 offen sc1
    s_waitcnt vmcnt(30)
    v_mfma_f32_32x32x16_bf16 v[192:207], v[92:95], v[176:179], v[192:207]
    v_mfma_f32_32x32x16_bf16 v[208:223], v[92:95], v[180:183], v[208:223]
    v_mfma_f32_32x32x16_bf16 v[224:239], v[96:99], v[176:179], v[224:239]
    v_mfma_f32_32x32x16_bf16 v[240:255], v[96:99], v[180:183], v[240:255]
    s_mov_b32 s78, 0
    s_branch L_sqc6
L_sq6:
    s_load_dword s71, s[60:61], 8 glc
    s_load_dword s72, s[60:61], 136 glc
    s_load_dword s73, s[60:61], 264 glc
    s_load_dword s74, s[60:61], 392 glc
    s_load_dword s75, s[60:61], 520 glc
    s_load_dword s76, s[60:61], 648 glc
    s_load_dword s79, s[60:61], 776 glc
L_sqc6:
    s_add_u32 s78, s78, 1
    s_waitcnt lgkmcnt(0)
    s_xor_b32 s71, s71, s87
    s_xor_b32 s72, s72, s87
    s_or_b32 s71, s71, s72
    s_xor_b32 s73, s73, s87
    s_or_b32 s71, s71, s73
    s_xor_b32 s74, s74, s87
    s_or_b32 s71, s71, s74
    s_xor_b32 s75, s75, s87
    s_or_b32 s71, s71, s75
    s_xor_b32 s76, s76, s87
    s_or_b32 s71, s71, s76
    s_xor_b32 s79, s79, s87
    s_or_b32 s71, s71, s79
    s_cbranch_scc0 L_sqd6
    s_sleep 2
    s_cmp_lt_u32 s78, 0x2000
    s_cbranch_scc1 L_sq6
L_sqd6:
    s_add_u32 s96, s96, 28672
    s_addc_u32 s97, s97, 0
    s_sub_u32 s98, s98, 28672
    buffer_load_dwordx4 v[176:179], v70, s[96:99], s44 offen sc1
    buffer_load_dwordx4 v[180:183], v74, s[96:99], s44 offen sc1
    s_waitcnt vmcnt(22)
    v_mfma_f32_32x32x16_bf16 v[192:207], v[100:103], v[184:187], v[192:207]
    v_mfma_f32_32x32x16_bf16 v[208:223], v[100:103], v[188:191], v[208:223]
    v_mfma_f32_32x32x16_bf16 v[224:239], v[104:107], v[184:187], v[224:239]
    v_mfma_f32_32x32x16_bf16 v[240:255], v[104:107], v[188:191], v[240:255]
    buffer_load_dwordx4 v[184:187], v70, s[96:99], s45 offen sc1
    buffer_load_dwordx4 v[188:191], v74, s[96:99], s45 offen sc1
    s_waitcnt vmcnt(20)
    ds_read_b64_tr_b16 v[24:25], v66 offset:49152
    ds_read_b64_tr_b16 v[26:27], v66 offset:49664
    ds_read_b64_tr_b16 v[28:29], v67 offset:49152
    ds_read_b64_tr_b16 v[30:31], v67 offset:49664
    v_mfma_f32_32x32x16_bf16 v[192:207], v[108:111], v[128:131], v[192:207]
    v_mfma_f32_32x32x16_bf16 v[208:223], v[108:111], v[132:135], v[208:223]
    v_mfma_f32_32x32x16_bf16 v[224:239], v[112:115], v[128:131], v[224:239]
    v_mfma_f32_32x32x16_bf16 v[240:255], v[112:115], v[132:135], v[240:255]
    buffer_load_dwordx4 v[128:131], v70, s[96:99], s46 offen sc1
    buffer_load_dwordx4 v[132:135], v74, s[96:99], s46 offen sc1
    s_load_dword s71, s[60:61], 12 glc
    s_load_dword s72, s[60:61], 140 glc
    s_load_dword s73, s[60:61], 268 glc
    s_load_dword s74, s[60:61], 396 glc
    s_load_dword s75, s[60:61], 524 glc
    s_load_dword s76, s[60:61], 652 glc
    s_load_dword s79, s[60:61], 780 glc
    s_waitcnt vmcnt(18)
    ds_read_b64_tr_b16 v[2:3], v66 offset:51200
    ds_read_b64_tr_b16 v[4:5], v66 offset:51712
    ds_read_b64_tr_b16 v[6:7], v67 offset:51200
    ds_read_b64_tr_b16 v[8:9], v67 offset:51712
    v_mfma_f32_32x32x16_bf16 v[192:207], v[116:119], v[136:139], v[192:207]
    v_mfma_f32_32x32x16_bf16 v[208:223], v[116:119], v[140:143], v[208:223]
    v_mfma_f32_32x32x16_bf16 v[224:239], v[120:123], v[136:139], v[224:239]
    v_mfma_f32_32x32x16_bf16 v[240:255], v[120:123], v[140:143], v[240:255]
    buffer_load_dwordx4 v[136:139], v70, s[96:99], s47 offen sc1
    buffer_load_dwordx4 v[140:143], v74, s[96:99], s47 offen sc1
    s_waitcnt vmcnt(16)
    ds_read_b64_tr_b16 v[16:17], v66 offset:32768
    ds_read_b64_tr_b16 v[18:19], v66 offset:33280
    ds_read_b64_tr_b16 v[20:21], v67 offset:32768
    ds_read_b64_tr_b16 v[22:23], v67 offset:33280
    s_waitcnt lgkmcnt(8)
    v_mfma_f32_32x32x16_bf16 v[192:207], v[24:27], v[144:147], v[192:207]
    v_mfma_f32_32x32x16_bf16 v[208:223], v[24:27], v[148:151], v[208:223]
    v_mfma_f32_32x32x16_bf16 v[224:239], v[28:31], v[144:147], v[224:239]
    v_mfma_f32_32x32x16_bf16 v[240:255], v[28:31], v[148:151], v[240:255]
    buffer_load_dwordx4 v[144:147], v70, s[96:99], s48 offen sc1
    buffer_load_dwordx4 v[148:151], v74, s[96:99], s48 offen sc1
    s_waitcnt vmcnt(14)
    ds_read_b64_tr_b16 v[24:25], v66 offset:34816
    ds_read_b64_tr_b16 v[26:27], v66 offset:35328
    ds_read_b64_tr_b16 v[28:29], v67 offset:34816
    ds_read_b64_tr_b16 v[30:31], v67 offset:35328
    s_waitcnt lgkmcnt(8)
    v_mfma_f32_32x32x16_bf16 v[192:207], v[2:5], v[152:155], v[192:207]
    v_mfma_f32_32x32x16_bf16 v[208:223], v[2:5], v[156:159], v[208:223]
    v_mfma_f32_32x32x16_bf16 v[224:239], v[6:9], v[152:155], v[224:239]
    v_mfma_f32_32x32x16_bf16 v[240:255], v[6:9], v[156:159], v[240:255]
    buffer_load_dwordx4 v[152:155], v70, s[96:99], s49 offen sc1
    buffer_load_dwordx4 v[156:159], v74, s[96:99], s49 offen sc1
    s_waitcnt vmcnt(14)
    ds_read_b64_tr_b16 v[2:3], v10 offset:0
    ds_read_b64_tr_b16 v[4:5], v10 offset:512
    ds_read_b64_tr_b16 v[6:7], v11 offset:0
    ds_read_b64_tr_b16 v[8:9], v11 offset:512
    s_waitcnt lgkmcnt(8)
    v_mfma_f32_32x32x16_bf16 v[192:207], v[16:19], v[160:163], v[192:207]
    v_mfma_f32_32x32x16_bf16 v[208:223], v[16:19], v[164:167], v[208:223]
    v_mfma_f32_32x32x16_bf16 v[224:239], v[20:23], v[160:163], v[224:239]
    s_add_u32 m0, s3, 32768
    s_nop 0
    buffer_load_dwordx4 v64, s[16:19], s58 offen lds
    buffer_load_dwordx4 v75, s[16:19], s58 offen offset:1024 lds
    v_mfma_f32_32x32x16_bf16 v[240:255], v[20:23], v[164:167], v[240:255]
    buffer_load_dwordx4 v[160:163], v70, s[96:99], s50 offen sc1
    buffer_load_dwordx4 v[164:167], v74, s[96:99], s50 offen sc1
    s_waitcnt vmcnt(16)
    ds_read_b64_tr_b16 v[16:17], v10 offset:2048
    ds_read_b64_tr_b16 v[18:19], v10 offset:2560
    ds_read_b64_tr_b16 v[20:21], v11 offset:2048
    ds_read_b64_tr_b16 v[22:23], v11 offset:2560
    s_waitcnt lgkmcnt(8)
    v_mfma_f32_32x32x16_bf16 v[192:207], v[24:27], v[168:171], v[192:207]
    v_mfma_f32_32x32x16_bf16 v[208:223], v[24:27], v[172:175], v[208:223]
    v_mfma_f32_32x32x16_bf16 v[224:239], v[28:31], v[168:171], v[224:239]
    s_add_u32 s16, s16, 14336
    s_addc_u32 s17, s17, 0
    s_sub_u32 s18, s18, 14336
    s_add_u32 m0, s3, 34816
    s_nop 0
    buffer_load_dwordx4 v64, s[16:19], s52 offen lds
    buffer_load_dwordx4 v75, s[16:19], s52 offen offset:1024 lds
    v_mfma_f32_32x32x16_bf16 v[240:255], v[28:31], v[172:175], v[240:255]
    s_mov_b32 s78, 0
    s_branch L_sqc7
L_sq7:
    s_load_dword s71, s[60:61], 12 glc
    s_load_dword s72, s[60:61], 140 glc
    s_load_dword s73, s[60:61], 268 glc
    s_load_dword s74, s[60:61], 396 glc
    s_load_dword s75, s[60:61], 524 glc
    s_load_dword s76, s[60:61], 652 glc
    s_load_dword s79, s[60:61], 780 glc
L_sqc7:
    s_add_u32 s78, s78, 1
    s_waitcnt lgkmcnt(0)
    s_xor_b32 s71, s71, s87
    s_xor_b32 s72, s72, s87
    s_or_b32 s71, s71, s72
    s_xor_b32 s73, s73, s87
    s_or_b32 s71, s71, s73
    s_xor_b32 s74, s74, s87
    s_or_b32 s71, s71, s74
    s_xor_b32 s75, s75, s87
    s_or_b32 s71, s71, s75
    s_xor_b32 s76, s76, s87
    s_or_b32 s71, s71, s76
    s_xor_b32 s79, s79, s87
    s_or_b32 s71, s71, s79
    s_cbranch_scc0 L_sqd7
    s_sleep 2
    s_cmp_lt_u32 s78, 0x2000
    s_cbranch_scc1 L_sq7
L_sqd7:
    s_add_u32 s96, s96, 28672
    s_addc_u32 s97, s97, 0
    s_sub_u32 s98, s98, 28672
    buffer_load_dwordx4 v[168:171], v70, s[96:99], s44 offen sc1
    buffer_load_dwordx4 v[172:175], v74, s[96:99], s44 offen sc1
    s_waitcnt vmcnt(18)
    ds_read_b64_tr_b16 v[24:25], v66 offset:0
    ds_read_b64_tr_b16 v[26:27], v66 offset:512
    ds_read_b64_tr_b16 v[28:29], v67 offset:0
    ds_read_b64_tr_b16 v[30:31], v67 offset:512
    s_waitcnt lgkmcnt(8)
    v_mfma_f32_32x32x16_bf16 v[192:207], v[2:5], v[176:179], v[192:207]
    v_mfma_f32_32x32x16_bf16 v[208:223], v[2:5], v[180:183], v[208:223]
    v_mfma_f32_32x32x16_bf16 v[224:239], v[6:9], v[176:179], v[224:239]
    s_add_u32 m0, s3, 65536
    s_nop 0
    buffer_load_dwordx4 v64, s[16:19], s53 offen lds
    buffer_load_dwordx4 v75, s[16:19], s53 offen offset:1024 lds
    v_mfma_f32_32x32x16_bf16 v[240:255], v[6:9], v[180:183], v[240:255]
    buffer_load_dwordx4 v[176:179], v70, s[96:99], s45 offen sc1
    buffer_load_dwordx4 v[180:183], v74, s[96:99], s45 offen sc1
    s_waitcnt vmcnt(20)
    ds_read_b64_tr_b16 v[2:3], v66 offset:2048
    ds_read_b64_tr_b16 v[4:5], v66 offset:2560
    ds_read_b64_tr_b16 v[6:7], v67 offset:2048
    ds_read_b64_tr_b16 v[8:9], v67 offset:2560
    s_waitcnt lgkmcnt(8)
    v_mfma_f32_32x32x16_bf16 v[192:207], v[16:19], v[184:187], v[192:207]
    v_mfma_f32_32x32x16_bf16 v[208:223], v[16:19], v[188:191], v[208:223]
    v_mfma_f32_32x32x16_bf16 v[224:239], v[20:23], v[184:187], v[224:239]
    s_add_u32 m0, s3, 67584
    s_nop 0
    buffer_load_dwordx4 v64, s[16:19], s54 offen lds
    buffer_load_dwordx4 v75, s[16:19], s54 offen offset:1024 lds
    v_mfma_f32_32x32x16_bf16 v[240:255], v[20:23], v[188:191], v[240:255]
    buffer_load_dwordx4 v[184:187], v70, s[96:99], s46 offen sc1
    buffer_load_dwordx4 v[188:191], v74, s[96:99], s46 offen sc1
    s_waitcnt vmcnt(22)
    ds_read_b64_tr_b16 v[16:17], v66 offset:16384
    ds_read_b64_tr_b16 v[18:19], v66 offset:16896
    ds_read_b64_tr_b16 v[20:21], v67 offset:16384
    ds_read_b64_tr_b16 v[22:23], v67 offset:16896
    s_waitcnt lgkmcnt(8)
    v_mfma_f32_32x32x16_bf16 v[192:207], v[24:27], v[128:131], v[192:207]
    v_mfma_f32_32x32x16_bf16 v[208:223], v[24:27], v[132:135], v[208:223]
    v_mfma_f32_32x32x16_bf16 v[224:239], v[28:31], v[128:131], v[224:239]
    s_add_u32 m0, s3, 0
    s_nop 0
    buffer_load_dwordx4 v64, s[16:19], s55 offen lds
    buffer_load_dwordx4 v75, s[16:19], s55 offen offset:1024 lds
    v_mfma_f32_32x32x16_bf16 v[240:255], v[28:31], v[132:135], v[240:255]
    buffer_load_dwordx4 v[128:131], v70, s[96:99], s47 offen sc1
    buffer_load_dwordx4 v[132:135], v74, s[96:99], s47 offen sc1
    s_waitcnt vmcnt(24)
    ds_read_b64_tr_b16 v[24:25], v66 offset:18432
    ds_read_b64_tr_b16 v[26:27], v66 offset:18944
    ds_read_b64_tr_b16 v[28:29], v67 offset:18432
    ds_read_b64_tr_b16 v[30:31], v67 offset:18944
    s_waitcnt lgkmcnt(8)
    v_mfma_f32_32x32x16_bf16 v[192:207], v[2:5], v[136:139], v[192:207]
    v_mfma_f32_32x32x16_bf16 v[208:223], v[2:5], v[140:143], v[208:223]
    v_mfma_f32_32x32x16_bf16 v[224:239], v[6:9], v[136:139], v[224:239]
    s_add_u32 m0, s3, 2048
    s_nop 0
    buffer_load_dwordx4 v64, s[16:19], s56 offen lds
    buffer_load_dwordx4 v75, s[16:19], s56 offen offset:1024 lds
    v_mfma_f32_32x32x16_bf16 v[240:255], v[6:9], v[140:143], v[240:255]
    buffer_load_dwordx4 v[136:139], v70, s[96:99], s48 offen sc1
    buffer_load_dwordx4 v[140:143], v74, s[96:99], s48 offen sc1
    s_waitcnt vmcnt(22)
    ds_read_b64_tr_b16 v[2:3], v66 offset:32768
    ds_read_b64_tr_b16 v[4:5], v66 offset:33280
    ds_read_b64_tr_b16 v[6:7], v67 offset:32768
    ds_read_b64_tr_b16 v[8:9], v67 offset:33280
    s_waitcnt lgkmcnt(8)
    v_mfma_f32_32x32x16_bf16 v[192:207], v[16:19], v[144:147], v[192:207]
    v_mfma_f32_32x32x16_bf16 v[208:223], v[16:19], v[148:151], v[208:223]
    v_mfma_f32_32x32x16_bf16 v[224:239], v[20:23], v[144:147], v[224:239]
    s_add_u32 m0, s3, 16384
    s_nop 0
    buffer_load_dwordx4 v64, s[16:19], s57 offen lds
    buffer_load_dwordx4 v75, s[16:19], s57 offen offset:1024 lds
    v_mfma_f32_32x32x16_bf16 v[240:255], v[20:23], v[148:151], v[240:255]
    buffer_load_dwordx4 v[144:147], v70, s[96:99], s49 offen sc1
    buffer_load_dwordx4 v[148:151], v74, s[96:99], s49 offen sc1
    s_waitcnt vmcnt(22)
    ds_read_b64_tr_b16 v[16:17], v66 offset:34816
    ds_read_b64_tr_b16 v[18:19], v66 offset:35328
    ds_read_b64_tr_b16 v[20:21], v67 offset:34816
    ds_read_b64_tr_b16 v[22:23], v67 offset:35328
    s_waitcnt lgkmcnt(8)
    v_mfma_f32_32x32x16_bf16 v[192:207], v[24:27], v[152:155], v[192:207]
    v_mfma_f32_32x32x16_bf16 v[208:223], v[24:27], v[156:159], v[208:223]
    v_mfma_f32_32x32x16_bf16 v[224:239], v[28:31], v[152:155], v[224:239]
    s_add_u32 m0, s3, 18432
    s_nop 0
    buffer_load_dwordx4 v64, s[16:19], s58 offen lds
    buffer_load_dwordx4 v75, s[16:19], s58 offen offset:1024 lds
    v_mfma_f32_32x32x16_bf16 v[240:255], v[28:31], v[156:159], v[240:255]
    buffer_load_dwordx4 v[152:155], v70, s[96:99], s50 offen sc1
    buffer_load_dwordx4 v[156:159], v74, s[96:99], s50 offen sc1
    s_waitcnt vmcnt(22)
    ds_read_b64_tr_b16 v[24:25], v10 offset:0
    ds_read_b64_tr_b16 v[26:27], v10 offset:512
    ds_read_b64_tr_b16 v[28:29], v11 offset:0
    ds_read_b64_tr_b16 v[30:31], v11 offset:512
    s_waitcnt lgkmcnt(8)
    v_mfma_f32_32x32x16_bf16 v[192:207], v[2:5], v[160:163], v[192:207]
    v_mfma_f32_32x32x16_bf16 v[208:223], v[2:5], v[164:167], v[208:223]
    v_mfma_f32_32x32x16_bf16 v[224:239], v[6:9], v[160:163], v[224:239]
    v_mfma_f32_32x32x16_bf16 v[240:255], v[6:9], v[164:167], v[240:255]
    s_waitcnt vmcnt(18)
    ds_read_b64_tr_b16 v[2:3], v10 offset:2048
    ds_read_b64_tr_b16 v[4:5], v10 offset:2560
    ds_read_b64_tr_b16 v[6:7], v11 offset:2048
    ds_read_b64_tr_b16 v[8:9], v11 offset:2560
    s_waitcnt lgkmcnt(8)
    v_mfma_f32_32x32x16_bf16 v[192:207], v[16:19], v[168:171], v[192:207]
    v_mfma_f32_32x32x16_bf16 v[208:223], v[16:19], v[172:175], v[208:223]
    v_mfma_f32_32x32x16_bf16 v[224:239], v[20:23], v[168:171], v[224:239]
    v_mfma_f32_32x32x16_bf16 v[240:255], v[20:23], v[172:175], v[240:255]
    s_waitcnt vmcnt(14)
    ds_read_b64_tr_b16 v[16:17], v66 offset:0
    ds_read_b64_tr_b16 v[18:19], v66 offset:512
    ds_read_b64_tr_b16 v[20:21], v67 offset:0
    ds_read_b64_tr_b16 v[22:23], v67 offset:512
    s_waitcnt lgkmcnt(8)
    v_mfma_f32_32x32x16_bf16 v[192:207], v[24:27], v[176:179], v[192:207]
    v_mfma_f32_32x32x16_bf16 v[208:223], v[24:27], v[180:183], v[208:223]
    v_mfma_f32_32x32x16_bf16 v[224:239], v[28:31], v[176:179], v[224:239]
    v_mfma_f32_32x32x16_bf16 v[240:255], v[28:31], v[180:183], v[240:255]
    s_waitcnt vmcnt(10)
    ds_read_b64_tr_b16 v[24:25], v66 offset:2048
    ds_read_b64_tr_b16 v[26:27], v66 offset:2560
    ds_read_b64_tr_b16 v[28:29], v67 offset:2048
    ds_read_b64_tr_b16 v[30:31], v67 offset:2560
    s_waitcnt lgkmcnt(8)
    v_mfma_f32_32x32x16_bf16 v[192:207], v[2:5], v[184:187], v[192:207]
    v_mfma_f32_32x32x16_bf16 v[208:223], v[2:5], v[188:191], v[208:223]
    v_mfma_f32_32x32x16_bf16 v[224:239], v[6:9], v[184:187], v[224:239]
    v_mfma_f32_32x32x16_bf16 v[240:255], v[6:9], v[188:191], v[240:255]
    s_waitcnt vmcnt(6)
    ds_read_b64_tr_b16 v[2:3], v66 offset:16384
    ds_read_b64_tr_b16 v[4:5], v66 offset:16896
    ds_read_b64_tr_b16 v[6:7], v67 offset:16384
    ds_read_b64_tr_b16 v[8:9], v67 offset:16896
    s_waitcnt lgkmcnt(8)
    v_mfma_f32_32x32x16_bf16 v[192:207], v[16:19], v[128:131], v[192:207]
    v_mfma_f32_32x32x16_bf16 v[208:223], v[16:19], v[132:135], v[208:223]
    v_mfma_f32_32x32x16_bf16 v[224:239], v[20:23], v[128:131], v[224:239]
    v_mfma_f32_32x32x16_bf16 v[240:255], v[20:23], v[132:135], v[240:255]
    buffer_load_dword v14, v73, s[88:91], 0 offen sc1
    s_waitcnt vmcnt(3)
    ds_read_b64_tr_b16 v[16:17], v66 offset:18432
    ds_read_b64_tr_b16 v[18:19], v66 offset:18944
    ds_read_b64_tr_b16 v[20:21], v67 offset:18432
    ds_read_b64_tr_b16 v[22:23], v67 offset:18944
    s_waitcnt lgkmcnt(8)
    v_mfma_f32_32x32x16_bf16 v[192:207], v[24:27], v[136:139], v[192:207]
    v_mfma_f32_32x32x16_bf16 v[208:223], v[24:27], v[140:143], v[208:223]
    v_mfma_f32_32x32x16_bf16 v[224:239], v[28:31], v[136:139], v[224:239]
    v_mfma_f32_32x32x16_bf16 v[240:255], v[28:31], v[140:143], v[240:255]
    v_add_u32 v12, s3, v65
    v_xor_b32 v32, 12288, v12
    v_xor_b32 v33, 8192, v12
    v_xor_b32 v34, 4096, v12
    s_waitcnt vmcnt(0)
    v_cmp_ne_u32 vcc, s87, v14
    s_mov_b32 s40, 0
    s_nop 2
    s_cbranch_vccnz L_y_later
    s_add_u32 m0, s3, 49152
    s_add_u32 s77, s39, 0
    buffer_load_dwordx4 v69, s[20:23], s77 offen sc1 lds
    s_add_u32 m0, s3, 50176
    s_add_u32 s77, s39, 65536
    buffer_load_dwordx4 v69, s[20:23], s77 offen sc1 lds
    buffer_load_dword v56, v71, s[24:27], 0 offen sc1
    s_mov_b32 s40, 1
L_y_later:
    s_waitcnt lgkmcnt(0)
    v_mfma_f32_32x32x16_bf16 v[192:207], v[2:5], v[144:147], v[192:207]
    v_mfma_f32_32x32x16_bf16 v[192:207], v[16:19], v[152:155], v[192:207]
    v_mfma_f32_32x32x16_bf16 v[208:223], v[2:5], v[148:151], v[208:223]
    v_mfma_f32_32x32x16_bf16 v[208:223], v[16:19], v[156:159], v[208:223]
    s_nop 9
    ds_write_b128 v12, v[192:195] offset:0
    ds_write_b128 v12, v[196:199] offset:1024
    ds_write_b128 v12, v[200:203] offset:2048
    ds_write_b128 v12, v[204:207] offset:3072
    v_mfma_f32_32x32x16_bf16 v[224:239], v[6:9], v[144:147], v[224:239]
    v_mfma_f32_32x32x16_bf16 v[224:239], v[20:23], v[152:155], v[224:239]
    ds_write_b128 v12, v[208:211] offset:16384
    ds_write_b128 v12, v[212:215] offset:17408
    ds_write_b128 v12, v[216:219] offset:18432
    ds_write_b128 v12, v[220:223] offset:19456
    v_mfma_f32_32x32x16_bf16 v[240:255], v[6:9], v[148:151], v[240:255]
    v_mfma_f32_32x32x16_bf16 v[240:255], v[20:23], v[156:159], v[240:255]
    s_nop 5
    ds_write_b128 v12, v[224:227] offset:32768
    ds_write_b128 v12, v[228:231] offset:33792
    ds_write_b128 v12, v[232:235] offset:34816
    ds_write_b128 v12, v[236:239] offset:35840
    s_waitcnt lgkmcnt(0)
    s_barrier
    ds_read_b128 v[128:131], v32 offset:0
    ds_read_b128 v[132:135], v32 offset:1024
    ds_read_b128 v[136:139], v32 offset:2048
    ds_read_b128 v[140:143], v32 offset:3072
    ds_read_b128 v[144:147], v33 offset:16384
    ds_read_b128 v[148:151], v33 offset:17408
    ds_read_b128 v[152:155], v33 offset:18432
    ds_read_b128 v[156:159], v33 offset:19456
    ds_read_b128 v[160:163], v34 offset:32768
    ds_read_b128 v[164:167], v34 offset:33792
    ds_read_b128 v[168:171], v34 offset:34816
    ds_read_b128 v[172:175], v34 offset:35840
    s_cmp_eq_u32 s40, 1
    s_cbranch_scc1 L_y_have
    v_cmp_ne_u32 vcc, s87, v14
    s_nop 4
    s_cbranch_vccz L_wfd8
    s_mov_b32 s78, 0
L_wf8:
    s_sleep 2
    buffer_load_dword v14, v73, s[88:91], 0 offen sc1
    s_add_u32 s78, s78, 1
    s_waitcnt vmcnt(0)
    v_cmp_ne_u32 vcc, s87, v14
    s_nop 4
    s_cbranch_vccz L_wfd8
    s_cmp_lt_u32 s78, 0x4000
    s_cbranch_scc1 L_wf8
L_wfd8:
    s_nop 0
    s_add_u32 m0, s3, 49152
    s_add_u32 s77, s39, 0
    buffer_load_dwordx4 v69, s[20:23], s77 offen sc1 lds
    s_add_u32 m0, s3, 50176
    s_add_u32 s77, s39, 65536
    buffer_load_dwordx4 v69, s[20:23], s77 offen sc1 lds
    buffer_load_dword v56, v71, s[24:27], 0 offen sc1
L_y_have:
    s_nop 3
    s_waitcnt vmcnt(0)
    ds_read_b64_tr_b16 v[40:41], v127 offset:49152
    ds_read_b64_tr_b16 v[42:43], v127 offset:49664
    ds_read_b64_tr_b16 v[44:45], v127 offset:50176
    ds_read_b64_tr_b16 v[46:47], v127 offset:50688
    v_mov_b32 v57, v56
    v_sub_f32 v58, 1.0, v56
    v_cvt_pk_bf16_f32 v58, v58, v58
    v_and_b32 v58, 0xffff0000, v58
    v_mov_b32 v59, v58
    s_waitcnt lgkmcnt(12)
    v_pk_add_f32 v[128:129], v[128:129], v[240:241]
    v_pk_add_f32 v[130:131], v[130:131], v[242:243]
    v_pk_add_f32 v[132:133], v[132:133], v[244:245]
    v_pk_add_f32 v[134:135], v[134:135], v[246:247]
    v_pk_add_f32 v[136:137], v[136:137], v[248:249]
    v_pk_add_f32 v[138:139], v[138:139], v[250:251]
    v_pk_add_f32 v[140:141], v[140:141], v[252:253]
    v_pk_add_f32 v[142:143], v[142:143], v[254:255]
    s_waitcnt lgkmcnt(4)
    v_pk_add_f32 v[144:145], v[144:145], v[160:161]
    v_pk_add_f32 v[146:147], v[146:147], v[162:163]
    v_pk_add_f32 v[148:149], v[148:149], v[164:165]
    v_pk_add_f32 v[150:151], v[150:151], v[166:167]
    v_pk_add_f32 v[152:153], v[152:153], v[168:169]
    v_pk_add_f32 v[154:155], v[154:155], v[170:171]
    v_pk_add_f32 v[156:157], v[156:157], v[172:173]
    v_pk_add_f32 v[158:159], v[158:159], v[174:175]
    s_waitcnt lgkmcnt(0)
    v_lshlrev_b32 v76, 16, v40
    v_and_b32 v77, 0xffff0000, v40
    v_lshlrev_b32 v78, 16, v41
    v_and_b32 v79, 0xffff0000, v41
    v_lshlrev_b32 v80, 16, v42
    v_and_b32 v81, 0xffff0000, v42
    v_lshlrev_b32 v82, 16, v43
    v_and_b32 v83, 0xffff0000, v43
    v_lshlrev_b32 v84, 16, v44
    v_and_b32 v85, 0xffff0000, v44
    v_lshlrev_b32 v86, 16, v45
    v_and_b32 v87, 0xffff0000, v45
    v_lshlrev_b32 v88, 16, v46
    v_and_b32 v89, 0xffff0000, v46
    v_lshlrev_b32 v90, 16, v47
    v_and_b32 v91, 0xffff0000, v47
    v_pk_add_f32 v[128:129], v[128:129], v[144:145]
    v_pk_add_f32 v[130:131], v[130:131], v[146:147]
    v_pk_add_f32 v[132:133], v[132:133], v[148:149]
    v_pk_add_f32 v[134:135], v[134:135], v[150:151]
    v_pk_add_f32 v[136:137], v[136:137], v[152:153]
    v_pk_add_f32 v[138:139], v[138:139], v[154:155]
    v_pk_add_f32 v[140:141], v[140:141], v[156:157]
    v_pk_add_f32 v[142:143], v[142:143], v[158:159]
    v_pk_mul_f32 v[76:77], v[76:77], v[56:57]
    v_pk_mul_f32 v[78:79], v[78:79], v[56:57]
    v_pk_mul_f32 v[80:81], v[80:81], v[56:57]
    v_pk_mul_f32 v[82:83], v[82:83], v[56:57]
    v_pk_mul_f32 v[84:85], v[84:85], v[56:57]
    v_pk_mul_f32 v[86:87], v[86:87], v[56:57]
    v_pk_mul_f32 v[88:89], v[88:89], v[56:57]
    v_pk_mul_f32 v[90:91], v[90:91], v[56:57]
    v_pk_fma_f32 v[128:129], v[128:129], v[58:59], v[76:77]
    v_pk_fma_f32 v[130:131], v[130:131], v[58:59], v[78:79]
    v_pk_fma_f32 v[132:133], v[132:133], v[58:59], v[80:81]
    v_pk_fma_f32 v[134:135], v[134:135], v[58:59], v[82:83]
    v_pk_fma_f32 v[136:137], v[136:137], v[58:59], v[84:85]
    v_pk_fma_f32 v[138:139], v[138:139], v[58:59], v[86:87]
    v_pk_fma_f32 v[140:141], v[140:141], v[58:59], v[88:89]
    v_pk_fma_f32 v[142:143], v[142:143], v[58:59], v[90:91]
    v_cvt_pk_bf16_f32 v144, v128, v129
    v_cvt_pk_bf16_f32 v145, v130, v131
    v_cvt_pk_bf16_f32 v146, v132, v133
    v_cvt_pk_bf16_f32 v147, v134, v135
    v_cvt_pk_bf16_f32 v148, v136, v137
    v_cvt_pk_bf16_f32 v149, v138, v139
    v_cvt_pk_bf16_f32 v150, v140, v141
    v_cvt_pk_bf16_f32 v151, v142, v143
    ds_write_b64 v124, v[144:145] offset:0
    ds_write_b64 v124, v[146:147] offset:16
    ds_write_b64 v124, v[148:149] offset:32
    ds_write_b64 v124, v[150:151] offset:48
    s_waitcnt lgkmcnt(0)
    s_barrier
    ds_read_b128 v[160:163], v1
    ds_read_b128 v[164:167], v1 offset:1152
    s_add_u32 s77, s43, 7168
    s_waitcnt lgkmcnt(1)
    buffer_store_dwordx4 v[160:163], v68, s[32:35], s43 offen
    s_waitcnt lgkmcnt(0)
    buffer_store_dwordx4 v[164:167], v68, s[32:35], s77 offen
    s_endpgm
L_nonce:
    s_waitcnt lgkmcnt(0)
    s_add_u32 s88, s68, 11026432
    s_addc_u32 s89, s69, 0
    s_mov_b32 s90, 294912
    s_mov_b32 s91, 0x20000
    s_mov_b32 s92, s66
    s_mov_b32 s93, s67
    s_mov_b32 s94, 256
    s_mov_b32 s95, 0x20000
    s_mov_b64 exec, 1
    v_mov_b32 v1, 237568
    buffer_load_dword v2, v1, s[88:91], 0 offen sc1
    s_mov_b32 s77, 0x9e3779b1
    v_mov_b32 v3, 0
    s_waitcnt vmcnt(0)
    v_mul_lo_u32 v2, v2, s77
    v_add_u32 v2, 0x7f4a7c15, v2
    v_or_b32 v2, 1, v2
    buffer_store_dword v2, v3, s[92:95], 0 offen sc1
    buffer_store_dword v2, v1, s[88:91], 0 offen sc1
    s_mov_b64 exec, -1
    s_branch L_nopf
L_SP:
    s_nop 1
    s_cmp_lt_u32 s2, 256
    s_cbranch_scc1 L_P
    s_sub_u32 s101, s2, 256
    s_lshr_b32 s77, s70, 1
    s_lshl_b32 s81, s101, 1
    s_add_u32 s81, s81, s77
    s_and_b32 s84, s70, 1
    s_lshl_b32 s77, s84, 8
    s_lshl_b32 s83, s81, 9
    s_add_u32 s83, s83, s77
    v_lshlrev_b32 v11, 2, v0
    s_lshl_b32 s77, s101, 2
    s_waitcnt lgkmcnt(0)
    s_load_dword s82, s[50:51], s77
    s_load_dword s75, s[52:53], s77
    s_mov_b32 s16, s38
    s_mov_b32 s17, s39
    s_mov_b32 s18, 229376
    s_mov_b32 s19, 0x20000
    buffer_load_dword v64, v11, s[16:19], s83 offen
    s_mov_b32 s20, s40
    s_mov_b32 s21, s41
    s_mov_b32 s22, 229376
    s_mov_b32 s23, 0x20000
    buffer_load_dword v65, v11, s[20:23], s83 offen
    s_mov_b32 s24, s42
    s_mov_b32 s25, s43
    s_mov_b32 s26, 229376
    s_mov_b32 s27, 0x20000
    buffer_load_dword v66, v11, s[24:27], s83 offen
    s_mov_b32 s16, s44
    s_mov_b32 s17, s45
    s_mov_b32 s18, 229376
    s_mov_b32 s19, 0x20000
    buffer_load_dword v67, v11, s[16:19], s83 offen
    s_mov_b32 s20, s46
    s_mov_b32 s21, s47
    s_mov_b32 s22, 229376
    s_mov_b32 s23, 0x20000
    buffer_load_dword v68, v11, s[20:23], s83 offen
    s_mov_b32 s24, s48
    s_mov_b32 s25, s49
    s_mov_b32 s26, 229376
    s_mov_b32 s27, 0x20000
    buffer_load_dword v69, v11, s[24:27], s83 offen
    s_mov_b32 s28, s60
    s_mov_b32 s29, s61
    s_mov_b32 s30, 1605632
    s_mov_b32 s31, 0x20000
    s_lshl_b32 s77, s101, 2
    s_add_u32 s77, s77, s70
    s_mul_i32 s77, s77, 1792
    v_lshlrev_b32 v10, 4, v0
    buffer_load_dwordx4 v[248:251], v10, s[28:31], s77 offen
    buffer_load_dwordx4 v[252:255], v10, s[28:31], s77 offen offset:768
    s_add_u32 s88, s68, 11026432
    s_addc_u32 s89, s69, 0
    s_mov_b32 s90, 294912
    s_mov_b32 s91, 0x20000
    s_mov_b32 s92, s66
    s_mov_b32 s93, s67
    s_mov_b32 s94, 256
    s_mov_b32 s95, 0x20000
    s_mul_i32 s77, s70, 17408
    s_mov_b32 m0, s77
    v_and_b32 v75, 31, v0
    v_mul_u32_u24 v75, 272, v75
    v_lshrrev_b32 v76, 5, v0
    v_lshl_add_u32 v75, v76, 4, v75
    v_add_u32 v73, s77, v75
    s_waitcnt lgkmcnt(0)
    s_lshl_b32 s77, s82, 16
    s_and_b32 s78, s82, 0xffff0000
    s_cmp_ge_u32 s70, 2
    s_cselect_b32 s77, s78, s77
    s_cselect_b32 s76, 0, 16
    s_lshl_b32 s75, s75, s76
    s_and_b32 s75, s75, 0xffff0000
    v_mov_b32 v75, s77
    v_mul_f32 v76, 0x3fb8aa3b, v75
    v_mov_b32 v77, 0x3fb8aa3b
    v_fma_f32 v77, v75, v77, -v76
    v_fmac_f32 v77, 0x32a57060, v75
    v_exp_f32 v76, v76
    v_mul_f32 v77, 0x3f317218, v77
    v_fma_f32 v76, v76, v77, v76
    v_cvt_pk_bf16_f32 v76, v76, v76
    v_and_b32 v74, 0xffff0000, v76
    s_waitcnt vmcnt(2)
    v_lshlrev_b32 v80, 16, v64
    v_lshlrev_b32 v81, 16, v65
    v_lshlrev_b32 v82, 16, v66
    v_lshlrev_b32 v83, 16, v67
    v_lshlrev_b32 v85, 16, v68
    v_lshlrev_b32 v86, 16, v69
    v_mul_f32 v80, v74, v80
    v_mul_f32 v81, v74, v81
    v_mul_f32 v82, v74, v82
    v_mul_f32 v83, v74, v83
    v_mul_f32 v80, 0x3fb8aa3b, v80
    v_mul_f32 v81, 0.15915494, v81
    v_xor_b32 v84, 0x80000000, v83
    v_mul_f32 v102, v85, v82
    v_mul_f32 v103, v86, v82
    v_fmac_f32 v102, v86, v84
    v_fmac_f32 v103, v85, v83
    v_exp_f32 v110, v80
    v_fract_f32 v111, v81
    v_cos_f32 v87, v111
    v_sin_f32 v88, v111
    v_mul_f32 v87, v87, v110
    v_mul_f32 v88, v88, v110
    v_xor_b32 v89, 0x80000000, v88
    v_mul_f32 v110, 0x41000000, v80
    v_mul_f32 v111, 0x41000000, v81
    v_exp_f32 v110, v110
    v_fract_f32 v111, v111
    v_cos_f32 v96, v111
    v_sin_f32 v97, v111
    v_mul_f32 v96, v96, v110
    v_mul_f32 v97, v97, v110
    v_xor_b32 v98, 0x80000000, v97
    v_mul_f32 v110, 0x43800000, v80
    v_mul_f32 v111, 0x43800000, v81
    v_exp_f32 v110, v110
    v_fract_f32 v111, v111
    v_cos_f32 v99, v111
    v_sin_f32 v100, v111
    v_mul_f32 v99, v99, v110
    v_mul_f32 v100, v100, v110
    v_xor_b32 v101, 0x80000000, v100
    v_mul_f32 v90, v87, v87
    v_mul_f32 v91, v88, v87
    v_fmac_f32 v90, v88, v89
    v_fmac_f32 v91, v87, v88
    v_xor_b32 v92, 0x80000000, v91
    v_mul_f32 v93, v90, v90
    v_mul_f32 v94, v91, v90
    v_fmac_f32 v93, v91, v92
    v_fmac_f32 v94, v90, v91
    v_xor_b32 v95, 0x80000000, v94
    v_cvt_pk_bf16_f32 v128, v102, -v103
    v_mul_f32 v106, v102, v99
    v_mul_f32 v107, v103, v99
    v_fmac_f32 v106, v103, v101
    v_fmac_f32 v107, v102, v100
    v_cvt_pk_bf16_f32 v129, v106, -v107
    v_mul_f32 v104, v102, v87
    v_mul_f32 v105, v103, v87
    v_fmac_f32 v104, v103, v89
    v_fmac_f32 v105, v102, v88
    v_cvt_pk_bf16_f32 v130, v104, -v105
    v_mul_f32 v102, v104, v87
    v_mul_f32 v103, v105, v87
    v_fmac_f32 v102, v105, v89
    v_fmac_f32 v103, v104, v88
    v_cvt_pk_bf16_f32 v131, v102, -v103
    v_mul_f32 v104, v102, v87
    v_mul_f32 v105, v103, v87
    v_fmac_f32 v104, v103, v89
    v_fmac_f32 v105, v102, v88
    v_cvt_pk_bf16_f32 v132, v104, -v105
    v_mul_f32 v102, v104, v87
    v_mul_f32 v103, v105, v87
    v_fmac_f32 v102, v105, v89
    v_fmac_f32 v103, v104, v88
    v_cvt_pk_bf16_f32 v133, v102, -v103
    v_mul_f32 v104, v102, v87
    v_mul_f32 v105, v103, v87
    v_fmac_f32 v104, v103, v89
    v_fmac_f32 v105, v102, v88
    v_cvt_pk_bf16_f32 v134, v104, -v105
    v_mul_f32 v102, v104, v87
    v_mul_f32 v103, v105, v87
    v_fmac_f32 v102, v105, v89
    v_fmac_f32 v103, v104, v88
    v_cvt_pk_bf16_f32 v135, v102, -v103
    v_mul_f32 v104, v102, v87
    v_mul_f32 v105, v103, v87
    v_fmac_f32 v104, v103, v89
    v_fmac_f32 v105, v102, v88
    v_cvt_pk_bf16_f32 v136, v104, -v105
    v_mul_f32 v102, v106, v90
    v_mul_f32 v103, v107, v90
    v_fmac_f32 v102, v107, v92
    v_fmac_f32 v103, v106, v91
    v_cvt_pk_bf16_f32 v137, v102, -v103
    v_mul_f32 v104, v102, v90
    v_mul_f32 v105, v103, v90
    v_fmac_f32 v104, v103, v92
    v_fmac_f32 v105, v102, v91
    v_cvt_pk_bf16_f32 v138, v104, -v105
    v_mul_f32 v102, v104, v90
    v_mul_f32 v103, v105, v90
    v_fmac_f32 v102, v105, v92
    v_fmac_f32 v103, v104, v91
    v_cvt_pk_bf16_f32 v139, v102, -v103
    v_mul_f32 v104, v102, v90
    v_mul_f32 v105, v103, v90
    v_fmac_f32 v104, v103, v92
    v_fmac_f32 v105, v102, v91
    v_cvt_pk_bf16_f32 v140, v104, -v105
    v_mul_f32 v108, v106, v99
    v_mul_f32 v109, v107, v99
    v_fmac_f32 v108, v107, v101
    v_fmac_f32 v109, v106, v100
    v_cvt_pk_bf16_f32 v141, v108, -v109
    v_mul_f32 v102, v108, v93
    v_mul_f32 v103, v109, v93
    v_fmac_f32 v102, v109, v95
    v_fmac_f32 v103, v108, v94
    v_cvt_pk_bf16_f32 v142, v102, -v103
    v_mul_f32 v104, v102, v93
    v_mul_f32 v105, v103, v93
    v_fmac_f32 v104, v103, v95
    v_fmac_f32 v105, v102, v94
    v_cvt_pk_bf16_f32 v143, v104, -v105
    v_mul_f32 v106, v108, v99
    v_mul_f32 v107, v109, v99
    v_fmac_f32 v106, v109, v101
    v_fmac_f32 v107, v108, v100
    v_cvt_pk_bf16_f32 v144, v106, -v107
    v_mul_f32 v102, v106, v93
    v_mul_f32 v103, v107, v93
    v_fmac_f32 v102, v107, v95
    v_fmac_f32 v103, v106, v94
    v_cvt_pk_bf16_f32 v145, v102, -v103
    v_mul_f32 v104, v102, v93
    v_mul_f32 v105, v103, v93
    v_fmac_f32 v104, v103, v95
    v_fmac_f32 v105, v102, v94
    v_cvt_pk_bf16_f32 v146, v104, -v105
    v_mul_f32 v108, v106, v99
    v_mul_f32 v109, v107, v99
    v_fmac_f32 v108, v107, v101
    v_fmac_f32 v109, v106, v100
    v_cvt_pk_bf16_f32 v147, v108, -v109
    v_mul_f32 v102, v108, v96
    v_mul_f32 v103, v109, v96
    v_fmac_f32 v102, v109, v98
    v_fmac_f32 v103, v108, v97
    v_cvt_pk_bf16_f32 v148, v102, -v103
    v_mul_f32 v106, v108, v99
    v_mul_f32 v107, v109, v99
    v_fmac_f32 v106, v109, v101
    v_fmac_f32 v107, v108, v100
    v_cvt_pk_bf16_f32 v149, v106, -v107
    v_mul_f32 v102, v106, v96
    v_mul_f32 v103, v107, v96
    v_fmac_f32 v102, v107, v98
    v_fmac_f32 v103, v106, v97
    v_cvt_pk_bf16_f32 v150, v102, -v103
    v_mul_f32 v108, v106, v99
    v_mul_f32 v109, v107, v99
    v_fmac_f32 v108, v107, v101
    v_fmac_f32 v109, v106, v100
    v_cvt_pk_bf16_f32 v151, v108, -v109
    v_mul_f32 v102, v108, v96
    v_mul_f32 v103, v109, v96
    v_fmac_f32 v102, v109, v98
    v_fmac_f32 v103, v108, v97
    v_cvt_pk_bf16_f32 v152, v102, -v103
    v_mul_f32 v106, v108, v99
    v_mul_f32 v107, v109, v99
    v_fmac_f32 v106, v109, v101
    v_fmac_f32 v107, v108, v100
    v_cvt_pk_bf16_f32 v153, v106, -v107
    v_mul_f32 v102, v106, v96
    v_mul_f32 v103, v107, v96
    v_fmac_f32 v102, v107, v98
    v_fmac_f32 v103, v106, v97
    v_cvt_pk_bf16_f32 v154, v102, -v103
    v_cvt_pk_bf16_f32 v155, v96, v97
    v_mul_f32 v76, v96, v96
    v_mul_f32 v77, v97, v96
    v_fmac_f32 v76, v97, v98
    v_fmac_f32 v77, v96, v97
    v_cvt_pk_bf16_f32 v156, v76, v77
    v_mul_f32 v78, v76, v96
    v_mul_f32 v79, v77, v96
    v_fmac_f32 v78, v77, v98
    v_fmac_f32 v79, v76, v97
    v_cvt_pk_bf16_f32 v157, v78, v79
    v_mul_f32 v76, v78, v96
    v_mul_f32 v77, v79, v96
    v_fmac_f32 v76, v79, v98
    v_fmac_f32 v77, v78, v97
    v_cvt_pk_bf16_f32 v158, v76, v77
    v_mul_f32 v78, v76, v96
    v_mul_f32 v79, v77, v96
    v_fmac_f32 v78, v77, v98
    v_fmac_f32 v79, v76, v97
    v_cvt_pk_bf16_f32 v159, v78, v79
    v_mul_f32 v76, v78, v96
    v_mul_f32 v77, v79, v96
    v_fmac_f32 v76, v79, v98
    v_fmac_f32 v77, v78, v97
    v_cvt_pk_bf16_f32 v160, v76, v77
    v_mul_f32 v78, v76, v96
    v_mul_f32 v79, v77, v96
    v_fmac_f32 v78, v77, v98
    v_fmac_f32 v79, v76, v97
    v_cvt_pk_bf16_f32 v161, v78, v79
    v_mul_f32 v76, v78, v96
    v_mul_f32 v77, v79, v96
    v_fmac_f32 v76, v79, v98
    v_fmac_f32 v77, v78, v97
    v_cvt_pk_bf16_f32 v162, v76, v77
    v_mul_f32 v78, v76, v96
    v_mul_f32 v79, v77, v96
    v_fmac_f32 v78, v77, v98
    v_fmac_f32 v79, v76, v97
    v_cvt_pk_bf16_f32 v163, v78, v79
    v_mul_f32 v76, v78, v96
    v_mul_f32 v77, v79, v96
    v_fmac_f32 v76, v79, v98
    v_fmac_f32 v77, v78, v97
    v_cvt_pk_bf16_f32 v164, v76, v77
    v_mul_f32 v78, v76, v96
    v_mul_f32 v79, v77, v96
    v_fmac_f32 v78, v77, v98
    v_fmac_f32 v79, v76, v97
    v_cvt_pk_bf16_f32 v165, v78, v79
    v_mul_f32 v76, v78, v96
    v_mul_f32 v77, v79, v96
    v_fmac_f32 v76, v79, v98
    v_fmac_f32 v77, v78, v97
    v_cvt_pk_bf16_f32 v166, v76, v77
    v_mul_f32 v78, v76, v96
    v_mul_f32 v79, v77, v96
    v_fmac_f32 v78, v77, v98
    v_fmac_f32 v79, v76, v97
    v_cvt_pk_bf16_f32 v167, v78, v79
    v_mul_f32 v76, v78, v96
    v_mul_f32 v77, v79, v96
    v_fmac_f32 v76, v79, v98
    v_fmac_f32 v77, v78, v97
    v_cvt_pk_bf16_f32 v168, v76, v77
    v_mul_f32 v78, v76, v96
    v_mul_f32 v79, v77, v96
    v_fmac_f32 v78, v77, v98
    v_fmac_f32 v79, v76, v97
    v_cvt_pk_bf16_f32 v169, v78, v79
    v_mul_f32 v76, v78, v96
    v_mul_f32 v77, v79, v96
    v_fmac_f32 v76, v79, v98
    v_fmac_f32 v77, v78, v97
    v_cvt_pk_bf16_f32 v170, v76, v77
    v_mul_f32 v78, v76, v96
    v_mul_f32 v79, v77, v96
    v_fmac_f32 v78, v77, v98
    v_fmac_f32 v79, v76, v97
    v_cvt_pk_bf16_f32 v171, v78, v79
    v_mul_f32 v76, v78, v96
    v_mul_f32 v77, v79, v96
    v_fmac_f32 v76, v79, v98
    v_fmac_f32 v77, v78, v97
    v_cvt_pk_bf16_f32 v172, v76, v77
    v_mul_f32 v78, v76, v96
    v_mul_f32 v79, v77, v96
    v_fmac_f32 v78, v77, v98
    v_fmac_f32 v79, v76, v97
    v_cvt_pk_bf16_f32 v173, v78, v79
    v_mul_f32 v76, v78, v96
    v_mul_f32 v77, v79, v96
    v_fmac_f32 v76, v79, v98
    v_fmac_f32 v77, v78, v97
    v_cvt_pk_bf16_f32 v174, v76, v77
    v_mul_f32 v78, v76, v96
    v_mul_f32 v79, v77, v96
    v_fmac_f32 v78, v77, v98
    v_fmac_f32 v79, v76, v97
    v_cvt_pk_bf16_f32 v175, v78, v79
    v_mul_f32 v76, v78, v96
    v_mul_f32 v77, v79, v96
    v_fmac_f32 v76, v79, v98
    v_fmac_f32 v77, v78, v97
    v_cvt_pk_bf16_f32 v176, v76, v77
    v_mul_f32 v78, v76, v96
    v_mul_f32 v79, v77, v96
    v_fmac_f32 v78, v77, v98
    v_fmac_f32 v79, v76, v97
    v_cvt_pk_bf16_f32 v177, v78, v79
    v_mul_f32 v76, v78, v96
    v_mul_f32 v77, v79, v96
    v_fmac_f32 v76, v79, v98
    v_fmac_f32 v77, v78, v97
    v_cvt_pk_bf16_f32 v178, v76, v77
    v_mul_f32 v78, v76, v96
    v_mul_f32 v79, v77, v96
    v_fmac_f32 v78, v77, v98
    v_fmac_f32 v79, v76, v97
    v_cvt_pk_bf16_f32 v179, v78, v79
    v_mul_f32 v76, v78, v96
    v_mul_f32 v77, v79, v96
    v_fmac_f32 v76, v79, v98
    v_fmac_f32 v77, v78, v97
    v_cvt_pk_bf16_f32 v180, v76, v77
    v_mul_f32 v78, v76, v96
    v_mul_f32 v79, v77, v96
    v_fmac_f32 v78, v77, v98
    v_fmac_f32 v79, v76, v97
    v_cvt_pk_bf16_f32 v181, v78, v79
    v_mul_f32 v76, v78, v96
    v_mul_f32 v77, v79, v96
    v_fmac_f32 v76, v79, v98
    v_fmac_f32 v77, v78, v97
    v_cvt_pk_bf16_f32 v182, v76, v77
    v_mul_f32 v78, v76, v96
    v_mul_f32 v79, v77, v96
    v_fmac_f32 v78, v77, v98
    v_fmac_f32 v79, v76, v97
    v_cvt_pk_bf16_f32 v183, v78, v79
    v_mul_f32 v76, v78, v96
    v_mul_f32 v77, v79, v96
    v_fmac_f32 v76, v79, v98
    v_fmac_f32 v77, v78, v97
    v_cvt_pk_bf16_f32 v184, v76, v77
    v_mul_f32 v78, v76, v96
    v_mul_f32 v79, v77, v96
    v_fmac_f32 v78, v77, v98
    v_fmac_f32 v79, v76, v97
    v_cvt_pk_bf16_f32 v185, v78, v79
    v_mov_b32 v12, 0
    buffer_load_dword v13, v12, s[92:95], 0 offen sc1
    v_and_b32 v80, 0xffff0000, v64
    v_and_b32 v81, 0xffff0000, v65
    v_and_b32 v82, 0xffff0000, v66
    v_and_b32 v83, 0xffff0000, v67
    v_and_b32 v85, 0xffff0000, v68
    v_and_b32 v86, 0xffff0000, v69
    v_mul_f32 v80, v74, v80
    v_mul_f32 v81, v74, v81
    v_mul_f32 v82, v74, v82
    v_mul_f32 v83, v74, v83
    v_mul_f32 v80, 0x3fb8aa3b, v80
    v_mul_f32 v81, 0.15915494, v81
    v_xor_b32 v84, 0x80000000, v83
    v_mul_f32 v102, v85, v82
    v_mul_f32 v103, v86, v82
    v_fmac_f32 v102, v86, v84
    v_fmac_f32 v103, v85, v83
    v_exp_f32 v110, v80
    v_fract_f32 v111, v81
    v_cos_f32 v87, v111
    v_sin_f32 v88, v111
    v_mul_f32 v87, v87, v110
    v_mul_f32 v88, v88, v110
    v_xor_b32 v89, 0x80000000, v88
    v_mul_f32 v110, 0x41000000, v80
    v_mul_f32 v111, 0x41000000, v81
    v_exp_f32 v110, v110
    v_fract_f32 v111, v111
    v_cos_f32 v96, v111
    v_sin_f32 v97, v111
    v_mul_f32 v96, v96, v110
    v_mul_f32 v97, v97, v110
    v_xor_b32 v98, 0x80000000, v97
    v_mul_f32 v110, 0x43800000, v80
    v_mul_f32 v111, 0x43800000, v81
    v_exp_f32 v110, v110
    v_fract_f32 v111, v111
    v_cos_f32 v99, v111
    v_sin_f32 v100, v111
    v_mul_f32 v99, v99, v110
    v_mul_f32 v100, v100, v110
    v_xor_b32 v101, 0x80000000, v100
    v_mul_f32 v90, v87, v87
    v_mul_f32 v91, v88, v87
    v_fmac_f32 v90, v88, v89
    v_fmac_f32 v91, v87, v88
    v_xor_b32 v92, 0x80000000, v91
    v_mul_f32 v93, v90, v90
    v_mul_f32 v94, v91, v90
    v_fmac_f32 v93, v91, v92
    v_fmac_f32 v94, v90, v91
    v_xor_b32 v95, 0x80000000, v94
    v_cvt_pk_bf16_f32 v187, v102, -v103
    v_mul_f32 v106, v102, v99
    v_mul_f32 v107, v103, v99
    v_fmac_f32 v106, v103, v101
    v_fmac_f32 v107, v102, v100
    v_cvt_pk_bf16_f32 v188, v106, -v107
    v_mul_f32 v104, v102, v87
    v_mul_f32 v105, v103, v87
    v_fmac_f32 v104, v103, v89
    v_fmac_f32 v105, v102, v88
    v_cvt_pk_bf16_f32 v189, v104, -v105
    v_mul_f32 v102, v104, v87
    v_mul_f32 v103, v105, v87
    v_fmac_f32 v102, v105, v89
    v_fmac_f32 v103, v104, v88
    v_cvt_pk_bf16_f32 v190, v102, -v103
    v_mul_f32 v104, v102, v87
    v_mul_f32 v105, v103, v87
    v_fmac_f32 v104, v103, v89
    v_fmac_f32 v105, v102, v88
    v_cvt_pk_bf16_f32 v191, v104, -v105
    v_mul_f32 v102, v104, v87
    v_mul_f32 v103, v105, v87
    v_fmac_f32 v102, v105, v89
    v_fmac_f32 v103, v104, v88
    v_cvt_pk_bf16_f32 v192, v102, -v103
    v_mul_f32 v104, v102, v87
    v_mul_f32 v105, v103, v87
    v_fmac_f32 v104, v103, v89
    v_fmac_f32 v105, v102, v88
    v_cvt_pk_bf16_f32 v193, v104, -v105
    v_mul_f32 v102, v104, v87
    v_mul_f32 v103, v105, v87
    v_fmac_f32 v102, v105, v89
    v_fmac_f32 v103, v104, v88
    v_cvt_pk_bf16_f32 v194, v102, -v103
    v_mul_f32 v104, v102, v87
    v_mul_f32 v105, v103, v87
    v_fmac_f32 v104, v103, v89
    v_fmac_f32 v105, v102, v88
    v_cvt_pk_bf16_f32 v195, v104, -v105
    v_mul_f32 v102, v106, v90
    v_mul_f32 v103, v107, v90
    v_fmac_f32 v102, v107, v92
    v_fmac_f32 v103, v106, v91
    v_cvt_pk_bf16_f32 v196, v102, -v103
    v_mul_f32 v104, v102, v90
    v_mul_f32 v105, v103, v90
    v_fmac_f32 v104, v103, v92
    v_fmac_f32 v105, v102, v91
    v_cvt_pk_bf16_f32 v197, v104, -v105
    v_mul_f32 v102, v104, v90
    v_mul_f32 v103, v105, v90
    v_fmac_f32 v102, v105, v92
    v_fmac_f32 v103, v104, v91
    v_cvt_pk_bf16_f32 v198, v102, -v103
    v_mul_f32 v104, v102, v90
    v_mul_f32 v105, v103, v90
    v_fmac_f32 v104, v103, v92
    v_fmac_f32 v105, v102, v91
    v_cvt_pk_bf16_f32 v199, v104, -v105
    v_mul_f32 v108, v106, v99
    v_mul_f32 v109, v107, v99
    v_fmac_f32 v108, v107, v101
    v_fmac_f32 v109, v106, v100
    v_cvt_pk_bf16_f32 v200, v108, -v109
    v_mul_f32 v102, v108, v93
    v_mul_f32 v103, v109, v93
    v_fmac_f32 v102, v109, v95
    v_fmac_f32 v103, v108, v94
    v_cvt_pk_bf16_f32 v201, v102, -v103
    v_mul_f32 v104, v102, v93
    v_mul_f32 v105, v103, v93
    v_fmac_f32 v104, v103, v95
    v_fmac_f32 v105, v102, v94
    v_cvt_pk_bf16_f32 v202, v104, -v105
    v_mul_f32 v106, v108, v99
    v_mul_f32 v107, v109, v99
    v_fmac_f32 v106, v109, v101
    v_fmac_f32 v107, v108, v100
    v_cvt_pk_bf16_f32 v203, v106, -v107
    v_mul_f32 v102, v106, v93
    v_mul_f32 v103, v107, v93
    v_fmac_f32 v102, v107, v95
    v_fmac_f32 v103, v106, v94
    v_cvt_pk_bf16_f32 v204, v102, -v103
    v_mul_f32 v104, v102, v93
    v_mul_f32 v105, v103, v93
    v_fmac_f32 v104, v103, v95
    v_fmac_f32 v105, v102, v94
    v_cvt_pk_bf16_f32 v205, v104, -v105
    v_mul_f32 v108, v106, v99
    v_mul_f32 v109, v107, v99
    v_fmac_f32 v108, v107, v101
    v_fmac_f32 v109, v106, v100
    v_cvt_pk_bf16_f32 v206, v108, -v109
    v_mul_f32 v102, v108, v96
    v_mul_f32 v103, v109, v96
    v_fmac_f32 v102, v109, v98
    v_fmac_f32 v103, v108, v97
    v_cvt_pk_bf16_f32 v207, v102, -v103
    v_mul_f32 v106, v108, v99
    v_mul_f32 v107, v109, v99
    v_fmac_f32 v106, v109, v101
    v_fmac_f32 v107, v108, v100
    v_cvt_pk_bf16_f32 v208, v106, -v107
    v_mul_f32 v102, v106, v96
    v_mul_f32 v103, v107, v96
    v_fmac_f32 v102, v107, v98
    v_fmac_f32 v103, v106, v97
    v_cvt_pk_bf16_f32 v209, v102, -v103
    v_mul_f32 v108, v106, v99
    v_mul_f32 v109, v107, v99
    v_fmac_f32 v108, v107, v101
    v_fmac_f32 v109, v106, v100
    v_cvt_pk_bf16_f32 v210, v108, -v109
    v_mul_f32 v102, v108, v96
    v_mul_f32 v103, v109, v96
    v_fmac_f32 v102, v109, v98
    v_fmac_f32 v103, v108, v97
    v_cvt_pk_bf16_f32 v211, v102, -v103
    v_mul_f32 v106, v108, v99
    v_mul_f32 v107, v109, v99
    v_fmac_f32 v106, v109, v101
    v_fmac_f32 v107, v108, v100
    v_cvt_pk_bf16_f32 v212, v106, -v107
    v_mul_f32 v102, v106, v96
    v_mul_f32 v103, v107, v96
    v_fmac_f32 v102, v107, v98
    v_fmac_f32 v103, v106, v97
    v_cvt_pk_bf16_f32 v213, v102, -v103
    v_cvt_pk_bf16_f32 v214, v96, v97
    v_mul_f32 v76, v96, v96
    v_mul_f32 v77, v97, v96
    v_fmac_f32 v76, v97, v98
    v_fmac_f32 v77, v96, v97
    v_cvt_pk_bf16_f32 v215, v76, v77
    v_mul_f32 v78, v76, v96
    v_mul_f32 v79, v77, v96
    v_fmac_f32 v78, v77, v98
    v_fmac_f32 v79, v76, v97
    v_cvt_pk_bf16_f32 v216, v78, v79
    v_mul_f32 v76, v78, v96
    v_mul_f32 v77, v79, v96
    v_fmac_f32 v76, v79, v98
    v_fmac_f32 v77, v78, v97
    v_cvt_pk_bf16_f32 v217, v76, v77
    v_mul_f32 v78, v76, v96
    v_mul_f32 v79, v77, v96
    v_fmac_f32 v78, v77, v98
    v_fmac_f32 v79, v76, v97
    v_cvt_pk_bf16_f32 v218, v78, v79
    v_mul_f32 v76, v78, v96
    v_mul_f32 v77, v79, v96
    v_fmac_f32 v76, v79, v98
    v_fmac_f32 v77, v78, v97
    v_cvt_pk_bf16_f32 v219, v76, v77
    v_mul_f32 v78, v76, v96
    v_mul_f32 v79, v77, v96
    v_fmac_f32 v78, v77, v98
    v_fmac_f32 v79, v76, v97
    v_cvt_pk_bf16_f32 v220, v78, v79
    v_mul_f32 v76, v78, v96
    v_mul_f32 v77, v79, v96
    v_fmac_f32 v76, v79, v98
    v_fmac_f32 v77, v78, v97
    v_cvt_pk_bf16_f32 v221, v76, v77
    v_mul_f32 v78, v76, v96
    v_mul_f32 v79, v77, v96
    v_fmac_f32 v78, v77, v98
    v_fmac_f32 v79, v76, v97
    v_cvt_pk_bf16_f32 v222, v78, v79
    v_mul_f32 v76, v78, v96
    v_mul_f32 v77, v79, v96
    v_fmac_f32 v76, v79, v98
    v_fmac_f32 v77, v78, v97
    v_cvt_pk_bf16_f32 v223, v76, v77
    v_mul_f32 v78, v76, v96
    v_mul_f32 v79, v77, v96
    v_fmac_f32 v78, v77, v98
    v_fmac_f32 v79, v76, v97
    v_cvt_pk_bf16_f32 v224, v78, v79
    v_mul_f32 v76, v78, v96
    v_mul_f32 v77, v79, v96
    v_fmac_f32 v76, v79, v98
    v_fmac_f32 v77, v78, v97
    v_cvt_pk_bf16_f32 v225, v76, v77
    v_mul_f32 v78, v76, v96
    v_mul_f32 v79, v77, v96
    v_fmac_f32 v78, v77, v98
    v_fmac_f32 v79, v76, v97
    v_cvt_pk_bf16_f32 v226, v78, v79
    v_mul_f32 v76, v78, v96
    v_mul_f32 v77, v79, v96
    v_fmac_f32 v76, v79, v98
    v_fmac_f32 v77, v78, v97
    v_cvt_pk_bf16_f32 v227, v76, v77
    v_mul_f32 v78, v76, v96
    v_mul_f32 v79, v77, v96
    v_fmac_f32 v78, v77, v98
    v_fmac_f32 v79, v76, v97
    v_cvt_pk_bf16_f32 v228, v78, v79
    v_mul_f32 v76, v78, v96
    v_mul_f32 v77, v79, v96
    v_fmac_f32 v76, v79, v98
    v_fmac_f32 v77, v78, v97
    v_cvt_pk_bf16_f32 v229, v76, v77
    v_mul_f32 v78, v76, v96
    v_mul_f32 v79, v77, v96
    v_fmac_f32 v78, v77, v98
    v_fmac_f32 v79, v76, v97
    v_cvt_pk_bf16_f32 v230, v78, v79
    v_mul_f32 v76, v78, v96
    v_mul_f32 v77, v79, v96
    v_fmac_f32 v76, v79, v98
    v_fmac_f32 v77, v78, v97
    v_cvt_pk_bf16_f32 v231, v76, v77
    v_mul_f32 v78, v76, v96
    v_mul_f32 v79, v77, v96
    v_fmac_f32 v78, v77, v98
    v_fmac_f32 v79, v76, v97
    v_cvt_pk_bf16_f32 v232, v78, v79
    v_mul_f32 v76, v78, v96
    v_mul_f32 v77, v79, v96
    v_fmac_f32 v76, v79, v98
    v_fmac_f32 v77, v78, v97
    v_cvt_pk_bf16_f32 v233, v76, v77
    v_mul_f32 v78, v76, v96
    v_mul_f32 v79, v77, v96
    v_fmac_f32 v78, v77, v98
    v_fmac_f32 v79, v76, v97
    v_cvt_pk_bf16_f32 v234, v78, v79
    v_mul_f32 v76, v78, v96
    v_mul_f32 v77, v79, v96
    v_fmac_f32 v76, v79, v98
    v_fmac_f32 v77, v78, v97
    v_cvt_pk_bf16_f32 v235, v76, v77
    v_mul_f32 v78, v76, v96
    v_mul_f32 v79, v77, v96
    v_fmac_f32 v78, v77, v98
    v_fmac_f32 v79, v76, v97
    v_cvt_pk_bf16_f32 v236, v78, v79
    v_mul_f32 v76, v78, v96
    v_mul_f32 v77, v79, v96
    v_fmac_f32 v76, v79, v98
    v_fmac_f32 v77, v78, v97
    v_cvt_pk_bf16_f32 v237, v76, v77
    v_mul_f32 v78, v76, v96
    v_mul_f32 v79, v77, v96
    v_fmac_f32 v78, v77, v98
    v_fmac_f32 v79, v76, v97
    v_cvt_pk_bf16_f32 v238, v78, v79
    v_mul_f32 v76, v78, v96
    v_mul_f32 v77, v79, v96
    v_fmac_f32 v76, v79, v98
    v_fmac_f32 v77, v78, v97
    v_cvt_pk_bf16_f32 v239, v76, v77
    v_mul_f32 v78, v76, v96
    v_mul_f32 v79, v77, v96
    v_fmac_f32 v78, v77, v98
    v_fmac_f32 v79, v76, v97
    v_cvt_pk_bf16_f32 v240, v78, v79
    v_mul_f32 v76, v78, v96
    v_mul_f32 v77, v79, v96
    v_fmac_f32 v76, v79, v98
    v_fmac_f32 v77, v78, v97
    v_cvt_pk_bf16_f32 v241, v76, v77
    v_mul_f32 v78, v76, v96
    v_mul_f32 v79, v77, v96
    v_fmac_f32 v78, v77, v98
    v_fmac_f32 v79, v76, v97
    v_cvt_pk_bf16_f32 v242, v78, v79
    v_mul_f32 v76, v78, v96
    v_mul_f32 v77, v79, v96
    v_fmac_f32 v76, v79, v98
    v_fmac_f32 v77, v78, v97
    v_cvt_pk_bf16_f32 v243, v76, v77
    v_mul_f32 v78, v76, v96
    v_mul_f32 v79, v77, v96
    v_fmac_f32 v78, v77, v98
    v_fmac_f32 v79, v76, v97
    v_cvt_pk_bf16_f32 v244, v78, v79
    s_lshl_b32 s77, s81, 12
    s_add_u32 s8, s68, s77
    s_addc_u32 s9, s69, 0
    s_add_u32 s8, s8, 7340032
    s_addc_u32 s9, s9, 0
    s_mov_b32 s10, 4096
    s_mov_b32 s11, 0x20000
    s_add_u32 s12, s68, 9175040
    s_addc_u32 s13, s69, 0
    s_mov_b32 s14, 1835008
    s_mov_b32 s15, 0x20000
    s_lshl_b32 s77, s84, 10
    v_lshlrev_b32 v75, 4, v0
    v_add_u32 v75, s77, v75
    v_and_b32 v9, 31, v0
    v_lshlrev_b32 v9, 7, v9
    v_add_u32 v9, 229376, v9
    v_mov_b32 v76, 0x00003f80
    s_lshr_b32 s77, s70, 1
    s_mul_i32 s85, s77, 5120
    s_mul_i32 s86, s77, 16640
    s_add_u32 s86, s86, 10240
    s_lshl_b32 s77, s77, 12
    s_add_u32 s77, s77, 69632
    v_lshlrev_b32 v4, 4, v0
    v_add_u32 v77, s77, v4
    v_add_u32 v38, s85, v4
    v_and_b32 v4, 31, v0
    v_sub_u32 v5, 31, v4
    v_lshlrev_b32 v5, 4, v5
    v_lshrrev_b32 v6, 5, v0
    v_cmp_eq_u32 s[20:21], 1, v6
    v_sub_u32 v6, 1, v6
    v_lshl_add_u32 v5, v6, 3, v5
    v_add_u32 v78, s85, v5
    v_add_u32 v79, s86, v75
    v_and_b32 v5, 1, v0
    v_cmp_eq_u32 s[22:23], 0, v5
    v_lshrrev_b32 v6, 1, v0
    v_mul_u32_u24 v6, 4160, v6
    v_lshl_add_u32 v6, v5, 4, v6
    v_add_u32 v37, s86, v6
    v_and_b32 v4, 15, v0
    v_lshrrev_b32 v5, 4, v0
    v_lshlrev_b32 v6, 1, v4
    v_sub_u32 v6, v5, v6
    v_add_u32 v6, 30, v6
    v_lshlrev_b32 v6, 4, v6
    v_add_u32 v2, s85, v6
    v_add_u32 v7, 1, v4
    v_and_b32 v8, 3, v7
    v_sub_u32 v7, v7, v8
    v_lshl_add_u32 v7, v5, 3, v7
    v_lshlrev_b32 v7, 1, v7
    v_mul_u32_u24 v8, 4160, v8
    v_add_u32 v7, v7, v8
    v_add_u32 v3, s86, v7
    v_lshlrev_b32 v8, 5, v4
    v_lshl_add_u32 v8, v5, 3, v8
    v_mov_b32 v56, 0
    v_mov_b32 v57, 0
    v_mov_b32 v58, 0
    v_mov_b32 v59, 0
    v_mov_b32 v60, 0
    v_mov_b32 v61, 0
    v_mov_b32 v62, 0
    v_mov_b32 v63, 0
    v_mov_b32 v64, 0
    v_mov_b32 v65, 0
    v_mov_b32 v66, 0
    v_mov_b32 v67, 0
    v_mov_b32 v68, 0
    v_mov_b32 v69, 0
    v_mov_b32 v70, 0
    v_mov_b32 v71, 0
    v_mov_b32 v4, 0
    v_mov_b32 v5, 0
    v_mov_b32 v6, 0
    v_mov_b32 v7, 0
    s_lshl_b32 s71, s81, 12
    s_add_u32 s77, s86, 32
    v_add_u32 v72, s77, v8
    s_lshl_b32 s100, s101, 7
    s_add_u32 s100, s100, 114688
    s_waitcnt vmcnt(0)
    v_readfirstlane_b32 s87, v13
    s_nop 0
    s_cmp_lg_u32 s87, 0
    s_cbranch_scc1 L_gnd9
    s_mov_b32 s78, 0
L_gn9:
    buffer_load_dword v13, v12, s[92:95], 0 offen sc1
    s_waitcnt vmcnt(0)
    v_readfirstlane_b32 s87, v13
    s_add_u32 s78, s78, 1
    s_cmp_lg_u32 s87, 0
    s_cbranch_scc1 L_gnd9
    s_sleep 8
    s_cmp_lt_u32 s78, 0x2000
    s_cbranch_scc1 L_gn9
L_gnd9:
    s_nop 0
    s_cmp_lg_u32 s70, 0
    s_cbranch_scc1 L_mwd
    s_lshr_b32 s77, s101, 3
    s_lshl_b32 s77, s77, 2
    v_mov_b32 v12, s77
    s_mov_b32 s80, 0
L_m1:
    buffer_load_dword v13, v12, s[92:95], 0 offen offset:128 sc1
    s_add_u32 s80, s80, 1
    s_waitcnt vmcnt(0)
    v_readfirstlane_b32 s79, v13
    s_nop 0
    s_cmp_ge_u32 s79, 1
    s_cbranch_scc1 L_m1d
    s_sleep 3
    s_cmp_lt_u32 s80, 24
    s_cbranch_scc1 L_m1
L_m1d:
    buffer_load_dword v10, v9, s[88:91], 0 offen sc1
    s_waitcnt vmcnt(0)
    v_cmp_ne_u32 vcc, s87, v10
    s_nop 4
    s_cbranch_vccz L_wfd10
    s_mov_b32 s78, 0
L_wf10:
    s_sleep 8
    buffer_load_dword v10, v9, s[88:91], 0 offen sc1
    s_add_u32 s78, s78, 1
    s_waitcnt vmcnt(0)
    v_cmp_ne_u32 vcc, s87, v10
    s_nop 4
    s_cbranch_vccz L_wfd10
    s_cmp_lt_u32 s78, 0x4000
    s_cbranch_scc1 L_wf10
L_wfd10:
    s_nop 0
    s_mov_b32 s80, 0
L_m2:
    buffer_load_dword v13, v12, s[92:95], 0 offen offset:128 sc1
    s_add_u32 s80, s80, 1
    s_waitcnt vmcnt(0)
    v_readfirstlane_b32 s79, v13
    s_nop 0
    s_cmp_ge_u32 s79, 2
    s_cbranch_scc1 L_m2d
    s_sleep 3
    s_cmp_lt_u32 s80, 24
    s_cbranch_scc1 L_m2
L_m2d:
L_mwd:
    s_barrier
    buffer_load_dwordx4 v[16:19], v75, s[8:11], 0 offen offset:0 sc1
    buffer_load_dwordx4 v[20:23], v75, s[8:11], 0 offen offset:4 sc1
    buffer_load_dword v24, v75, s[8:11], 0 offen offset:20 sc1
    buffer_load_dwordx4 v[28:31], v75, s[8:11], 0 offen offset:2048 sc1
    buffer_load_dwordx4 v[32:35], v75, s[8:11], 0 offen offset:2052 sc1
    buffer_load_dword v36, v75, s[8:11], 0 offen offset:2068 sc1
    ds_write_addtid_b32 v76 offset:8704
    ds_write_addtid_b32 v128 offset:0
    ds_write_addtid_b32 v129 offset:2176
    ds_write_addtid_b32 v130 offset:272
    ds_write_addtid_b32 v131 offset:544
    ds_write_addtid_b32 v132 offset:816
    ds_write_addtid_b32 v133 offset:1088
    ds_write_addtid_b32 v134 offset:1360
    ds_write_addtid_b32 v135 offset:1632
    ds_write_addtid_b32 v136 offset:1904
    ds_write_addtid_b32 v137 offset:2448
    ds_write_addtid_b32 v138 offset:2720
    ds_write_addtid_b32 v138 offset:3264
    ds_write_addtid_b32 v139 offset:3536
    ds_write_addtid_b32 v140 offset:3808
    ds_write_addtid_b32 v141 offset:4352
    ds_write_addtid_b32 v142 offset:4624
    ds_write_addtid_b32 v142 offset:5440
    ds_write_addtid_b32 v143 offset:5712
    ds_write_addtid_b32 v144 offset:4896
    ds_write_addtid_b32 v145 offset:5168
    ds_write_addtid_b32 v145 offset:5984
    ds_write_addtid_b32 v146 offset:6256
    ds_write_addtid_b32 v147 offset:6528
    ds_write_addtid_b32 v148 offset:7616
    ds_write_addtid_b32 v149 offset:6800
    ds_write_addtid_b32 v150 offset:7888
    ds_write_addtid_b32 v151 offset:7072
    ds_write_addtid_b32 v152 offset:8160
    ds_write_addtid_b32 v153 offset:7344
    ds_write_addtid_b32 v154 offset:8432
    ds_write_addtid_b32 v155 offset:8976
    ds_write_addtid_b32 v156 offset:9248
    ds_write_addtid_b32 v157 offset:9520
    ds_write_addtid_b32 v158 offset:9792
    ds_write_addtid_b32 v159 offset:10064
    ds_write_addtid_b32 v160 offset:10336
    ds_write_addtid_b32 v161 offset:10608
    ds_write_addtid_b32 v162 offset:10880
    ds_write_addtid_b32 v163 offset:11152
    ds_write_addtid_b32 v164 offset:11424
    ds_write_addtid_b32 v165 offset:11696
    ds_write_addtid_b32 v166 offset:11968
    ds_write_addtid_b32 v167 offset:12240
    ds_write_addtid_b32 v168 offset:12512
    ds_write_addtid_b32 v169 offset:12784
    ds_write_addtid_b32 v170 offset:13056
    ds_write_addtid_b32 v171 offset:13328
    ds_write_addtid_b32 v172 offset:13600
    ds_write_addtid_b32 v173 offset:13872
    ds_write_addtid_b32 v174 offset:14144
    ds_write_addtid_b32 v175 offset:14416
    ds_write_addtid_b32 v176 offset:14688
    ds_write_addtid_b32 v177 offset:14960
    ds_write_addtid_b32 v178 offset:15232
    ds_write_addtid_b32 v179 offset:15504
    ds_write_addtid_b32 v180 offset:15776
    ds_write_addtid_b32 v181 offset:16048
    ds_write_addtid_b32 v182 offset:16320
    ds_write_addtid_b32 v183 offset:16592
    ds_write_addtid_b32 v184 offset:16864
    ds_write_addtid_b32 v185 offset:17136
    s_waitcnt lgkmcnt(0)
    ds_read_b128 v[80:83], v73 offset:0
    ds_read_b128 v[84:87], v73 offset:8704
    ds_read_b128 v[88:91], v73 offset:32
    ds_read_b128 v[92:95], v73 offset:8736
    ds_read_b128 v[96:99], v73 offset:64
    ds_read_b128 v[100:103], v73 offset:8768
    ds_read_b128 v[104:107], v73 offset:96
    ds_read_b128 v[108:111], v73 offset:8800
    s_waitcnt lgkmcnt(6)
    v_mfma_f32_32x32x16_bf16 v[112:127], v[80:83], v[84:87], 0
    ds_read_b128 v[80:83], v73 offset:128
    ds_read_b128 v[84:87], v73 offset:8832
    s_waitcnt lgkmcnt(6)
    v_mfma_f32_32x32x16_bf16 v[112:127], v[88:91], v[92:95], v[112:127]
    ds_read_b128 v[88:91], v73 offset:160
    ds_read_b128 v[92:95], v73 offset:8864
    s_waitcnt lgkmcnt(6)
    v_mfma_f32_32x32x16_bf16 v[112:127], v[96:99], v[100:103], v[112:127]
    ds_read_b128 v[96:99], v73 offset:192
    ds_read_b128 v[100:103], v73 offset:8896
    s_waitcnt lgkmcnt(6)
    v_mfma_f32_32x32x16_bf16 v[112:127], v[104:107], v[108:111], v[112:127]
    ds_read_b128 v[104:107], v73 offset:224
    ds_read_b128 v[108:111], v73 offset:8928
    s_waitcnt lgkmcnt(6)
    v_mfma_f32_32x32x16_bf16 v[112:127], v[80:83], v[84:87], v[112:127]
    s_waitcnt lgkmcnt(4)
    v_mfma_f32_32x32x16_bf16 v[112:127], v[88:91], v[92:95], v[112:127]
    s_waitcnt lgkmcnt(2)
    v_mfma_f32_32x32x16_bf16 v[112:127], v[96:99], v[100:103], v[112:127]
    s_waitcnt lgkmcnt(0)
    v_mfma_f32_32x32x16_bf16 v[112:127], v[104:107], v[108:111], v[112:127]
    ds_write_addtid_b32 v187 offset:0
    ds_write_addtid_b32 v188 offset:2176
    ds_write_addtid_b32 v189 offset:272
    ds_write_addtid_b32 v190 offset:544
    ds_write_addtid_b32 v191 offset:816
    ds_write_addtid_b32 v192 offset:1088
    ds_write_addtid_b32 v193 offset:1360
    ds_write_addtid_b32 v194 offset:1632
    ds_write_addtid_b32 v195 offset:1904
    ds_write_addtid_b32 v196 offset:2448
    ds_write_addtid_b32 v197 offset:2720
    ds_write_addtid_b32 v197 offset:3264
    ds_write_addtid_b32 v198 offset:3536
    ds_write_addtid_b32 v199 offset:3808
    ds_write_addtid_b32 v200 offset:4352
    ds_write_addtid_b32 v201 offset:4624
    ds_write_addtid_b32 v201 offset:5440
    ds_write_addtid_b32 v202 offset:5712
    ds_write_addtid_b32 v203 offset:4896
    ds_write_addtid_b32 v204 offset:5168
    ds_write_addtid_b32 v204 offset:5984
    ds_write_addtid_b32 v205 offset:6256
    ds_write_addtid_b32 v206 offset:6528
    ds_write_addtid_b32 v207 offset:7616
    ds_write_addtid_b32 v208 offset:6800
    ds_write_addtid_b32 v209 offset:7888
    ds_write_addtid_b32 v210 offset:7072
    ds_write_addtid_b32 v211 offset:8160
    ds_write_addtid_b32 v212 offset:7344
    ds_write_addtid_b32 v213 offset:8432
    ds_write_addtid_b32 v214 offset:8976
    ds_write_addtid_b32 v215 offset:9248
    ds_write_addtid_b32 v216 offset:9520
    ds_write_addtid_b32 v217 offset:9792
    ds_write_addtid_b32 v218 offset:10064
    ds_write_addtid_b32 v219 offset:10336
    ds_write_addtid_b32 v220 offset:10608
    ds_write_addtid_b32 v221 offset:10880
    ds_write_addtid_b32 v222 offset:11152
    ds_write_addtid_b32 v223 offset:11424
    ds_write_addtid_b32 v224 offset:11696
    ds_write_addtid_b32 v225 offset:11968
    ds_write_addtid_b32 v226 offset:12240
    ds_write_addtid_b32 v227 offset:12512
    ds_write_addtid_b32 v228 offset:12784
    ds_write_addtid_b32 v229 offset:13056
    ds_write_addtid_b32 v230 offset:13328
    ds_write_addtid_b32 v231 offset:13600
    ds_write_addtid_b32 v232 offset:13872
    ds_write_addtid_b32 v233 offset:14144
    ds_write_addtid_b32 v234 offset:14416
    ds_write_addtid_b32 v235 offset:14688
    ds_write_addtid_b32 v236 offset:14960
    ds_write_addtid_b32 v237 offset:15232
    ds_write_addtid_b32 v238 offset:15504
    ds_write_addtid_b32 v239 offset:15776
    ds_write_addtid_b32 v240 offset:16048
    ds_write_addtid_b32 v241 offset:16320
    ds_write_addtid_b32 v242 offset:16592
    ds_write_addtid_b32 v243 offset:16864
    ds_write_addtid_b32 v244 offset:17136
    s_waitcnt lgkmcnt(0)
    ds_read_b128 v[80:83], v73 offset:0
    ds_read_b128 v[84:87], v73 offset:8704
    ds_read_b128 v[88:91], v73 offset:32
    ds_read_b128 v[92:95], v73 offset:8736
    ds_read_b128 v[96:99], v73 offset:64
    ds_read_b128 v[100:103], v73 offset:8768
    ds_read_b128 v[104:107], v73 offset:96
    ds_read_b128 v[108:111], v73 offset:8800
    s_waitcnt lgkmcnt(6)
    v_mfma_f32_32x32x16_bf16 v[112:127], v[80:83], v[84:87], v[112:127]
    ds_read_b128 v[80:83], v73 offset:128
    ds_read_b128 v[84:87], v73 offset:8832
    s_waitcnt lgkmcnt(6)
    v_mfma_f32_32x32x16_bf16 v[112:127], v[88:91], v[92:95], v[112:127]
    ds_read_b128 v[88:91], v73 offset:160
    ds_read_b128 v[92:95], v73 offset:8864
    s_waitcnt lgkmcnt(6)
    v_mfma_f32_32x32x16_bf16 v[112:127], v[96:99], v[100:103], v[112:127]
    ds_read_b128 v[96:99], v73 offset:192
    ds_read_b128 v[100:103], v73 offset:8896
    s_waitcnt lgkmcnt(6)
    v_mfma_f32_32x32x16_bf16 v[112:127], v[104:107], v[108:111], v[112:127]
    ds_read_b128 v[104:107], v73 offset:224
    ds_read_b128 v[108:111], v73 offset:8928
    s_waitcnt lgkmcnt(6)
    v_mfma_f32_32x32x16_bf16 v[112:127], v[80:83], v[84:87], v[112:127]
    s_waitcnt lgkmcnt(4)
    v_mfma_f32_32x32x16_bf16 v[112:127], v[88:91], v[92:95], v[112:127]
    s_waitcnt lgkmcnt(2)
    v_mfma_f32_32x32x16_bf16 v[112:127], v[96:99], v[100:103], v[112:127]
    s_waitcnt lgkmcnt(0)
    v_mfma_f32_32x32x16_bf16 v[112:127], v[104:107], v[108:111], v[112:127]
    s_waitcnt vmcnt(0)
    s_cmp_lg_u32 s70, 0
    s_cbranch_scc1 L_ng
    v_add_u32 v11, 4096, v9
    buffer_load_dword v14, v11, s[88:91], 0 offen sc1
L_ng:
    s_cmp_eq_u32 s84, 1
    s_cbranch_scc1 L_x_hi
    s_nop 11
    ds_write_b128 v77, v[124:127] offset:3072
    s_branch L_x_done
L_x_hi:
    s_nop 11
    ds_write_b128 v77, v[112:115] offset:0
    ds_write_b128 v77, v[116:119] offset:1024
    ds_write_b128 v77, v[120:123] offset:2048
L_x_done:
    v_alignbit_b32 v40, v20, v16, 16
    v_alignbit_b32 v41, v21, v17, 16
    v_alignbit_b32 v42, v22, v18, 16
    v_alignbit_b32 v43, v23, v19, 16
    v_alignbit_b32 v44, v21, v20, 16
    v_alignbit_b32 v45, v22, v21, 16
    v_alignbit_b32 v46, v23, v22, 16
    v_alignbit_b32 v47, v24, v23, 16
    v_alignbit_b32 v48, v32, v28, 16
    v_alignbit_b32 v49, v33, v29, 16
    v_alignbit_b32 v50, v34, v30, 16
    v_alignbit_b32 v51, v35, v31, 16
    v_alignbit_b32 v52, v33, v32, 16
    v_alignbit_b32 v53, v34, v33, 16
    v_alignbit_b32 v54, v35, v34, 16
    v_alignbit_b32 v55, v36, v35, 16
    s_waitcnt lgkmcnt(0)
    s_barrier
    ds_read_b128 v[160:163], v77 offset:0
    ds_read_b128 v[164:167], v77 offset:1024
    ds_read_b128 v[168:171], v77 offset:2048
    ds_read_b128 v[172:175], v77 offset:3072
    ds_write_b128 v79, v[16:19] offset:32
    ds_write_b128 v79, v[40:43] offset:4192
    ds_write_b128 v79, v[20:23] offset:8352
    ds_write_b128 v79, v[44:47] offset:12512
    ds_write_b128 v79, v[28:31] offset:2080
    ds_write_b128 v79, v[48:51] offset:6240
    ds_write_b128 v79, v[32:35] offset:10400
    ds_write_b128 v79, v[52:55] offset:14560
    s_waitcnt lgkmcnt(8)
    v_add_f32 v112, v112, v160
    v_add_f32 v113, v113, v161
    v_add_f32 v114, v114, v162
    v_add_f32 v115, v115, v163
    v_add_f32 v116, v116, v164
    v_add_f32 v117, v117, v165
    v_add_f32 v118, v118, v166
    v_add_f32 v119, v119, v167
    v_add_f32 v120, v120, v168
    v_add_f32 v121, v121, v169
    v_add_f32 v122, v122, v170
    v_add_f32 v123, v123, v171
    v_add_f32 v124, v124, v172
    v_add_f32 v125, v125, v173
    v_add_f32 v126, v126, v174
    v_add_f32 v127, v127, v175
    s_cmp_eq_u32 s84, 1
    s_cbranch_scc1 L_exp_hi
    s_nop 1
    v_cvt_pk_bf16_f32 v84, v115, v114
    v_cvt_pk_bf16_f32 v85, v113, v112
    ds_write_b64 v78, v[84:85] offset:3584
    v_cvt_pk_bf16_f32 v86, v118, v117
    v_cvt_pk_bf16_f32 v87, v116, v116
    ds_write_b64 v78, v[86:87] offset:3072
    v_cndmask_b32 v92, v120, v121, s[20:21]
    v_cndmask_b32 v93, v122, v123, s[20:21]
    v_cvt_pk_bf16_f32 v88, v121, v92
    v_cvt_pk_bf16_f32 v89, v120, v120
    ds_write_b64 v78, v[88:89] offset:2560
    v_cvt_pk_bf16_f32 v90, v123, v93
    v_cvt_pk_bf16_f32 v91, v122, v122
    ds_write_b64 v78, v[90:91] offset:2048
    v_readfirstlane_b32 s72, v16
    v_readfirstlane_b32 s73, v40
    s_lshl_b32 s74, s72, 16
    v_writelane_b32 v7, s74, 3
    s_nop 0
    v_writelane_b32 v7, s72, 5
    v_writelane_b32 v7, s73, 7
    v_writelane_b32 v6, s74, 7
    s_mov_b64 exec, 0xff
    ds_write_b128 v37, v[4:7]
    s_mov_b64 exec, -1
    s_branch L_exp_done
L_exp_hi:
    s_nop 1
    v_mov_b32 v92, v124
    v_mov_b32 v93, v124
    v_mov_b32 v94, v125
    v_mov_b32 v95, v125
    v_mov_b32 v96, v126
    v_mov_b32 v97, v126
    v_mov_b32 v98, v127
    v_mov_b32 v99, v127
    v_permlane32_swap_b32 v92, v93
    v_permlane32_swap_b32 v94, v95
    v_permlane32_swap_b32 v96, v97
    v_permlane32_swap_b32 v98, v99
    v_cndmask_b32 v92, v124, v92, s[22:23]
    v_cndmask_b32 v94, v125, v94, s[22:23]
    v_cndmask_b32 v96, v126, v96, s[22:23]
    v_cndmask_b32 v98, v127, v98, s[22:23]
    v_cvt_pk_bf16_f32 v84, v124, v124
    v_cvt_pk_bf16_f32 v85, v124, v92
    ds_write_b64 v78, v[84:85] offset:1536
    v_cvt_pk_bf16_f32 v86, v125, v125
    v_cvt_pk_bf16_f32 v87, v125, v94
    ds_write_b64 v78, v[86:87] offset:1024
    v_cvt_pk_bf16_f32 v88, v126, v126
    v_cvt_pk_bf16_f32 v89, v126, v96
    ds_write_b64 v78, v[88:89] offset:512
    v_cvt_pk_bf16_f32 v90, v127, v127
    v_cvt_pk_bf16_f32 v91, v127, v98
    ds_write_b64 v78, v[90:91] offset:0
    ds_write_b128 v38, v[4:7] offset:4096
L_exp_done:
    s_mov_b32 s78, 0
    s_waitcnt lgkmcnt(0)
    s_barrier
    s_setprio 2
    s_cmp_eq_u32 s84, 1
    s_cbranch_scc1 L_conv1
L_conv0:
    s_nop 1
    ds_read_b64 v[176:177], v72 offset:0
    ds_read_b64 v[178:179], v72 offset:1536
    ds_read_b64 v[180:181], v72 offset:2048
    ds_read_b64 v[182:183], v72 offset:3584
    ds_read_b128 v[16:19], v2 offset:3584
    ds_read_b64 v[112:113], v3 offset:0
    ds_read_b64 v[114:115], v3 offset:8
    ds_read_b128 v[20:23], v2 offset:3072
    ds_read_b64 v[116:117], v3 offset:512
    ds_read_b64 v[118:119], v3 offset:520
    ds_read_b128 v[24:27], v2 offset:2560
    ds_read_b64 v[120:121], v3 offset:1024
    ds_read_b64 v[122:123], v3 offset:1032
    ds_read_b128 v[28:31], v2 offset:2048
    ds_read_b64 v[124:125], v3 offset:1536
    ds_read_b64 v[126:127], v3 offset:1544
    ds_read_b128 v[32:35], v2 offset:1536
    ds_read_b64 v[128:129], v3 offset:2048
    ds_read_b64 v[130:131], v3 offset:2056
    ds_read_b128 v[36:39], v2 offset:1024
    ds_read_b64 v[132:133], v3 offset:2560
    ds_read_b64 v[134:135], v3 offset:2568
    ds_read_b128 v[40:43], v2 offset:512
    ds_read_b64 v[136:137], v3 offset:3072
    ds_read_b64 v[138:139], v3 offset:3080
    ds_read_b128 v[44:47], v2 offset:0
    ds_read_b64 v[140:141], v3 offset:3584
    ds_read_b64 v[142:143], v3 offset:3592
L_cl0:
    s_waitcnt lgkmcnt(0)
    v_mfma_f32_16x16x32_bf16 v[56:59], v[112:115], v[16:19], v[56:59]
    ds_read_b128 v[80:83], v2 offset:3648
    ds_read_b64 v[144:145], v3 offset:64
    v_mfma_f32_16x16x32_bf16 v[60:63], v[120:123], v[20:23], v[60:63]
    ds_read_b64 v[146:147], v3 offset:72
    ds_read_b128 v[84:87], v2 offset:3136
    v_mfma_f32_16x16x32_bf16 v[60:63], v[116:119], v[24:27], v[60:63]
    ds_read_b64 v[148:149], v3 offset:576
    ds_read_b64 v[150:151], v3 offset:584
    v_mfma_f32_16x16x32_bf16 v[64:67], v[120:123], v[24:27], v[64:67]
    ds_read_b128 v[88:91], v2 offset:2624
    ds_read_b64 v[152:153], v3 offset:1088
    v_mfma_f32_16x16x32_bf16 v[60:63], v[124:127], v[16:19], v[60:63]
    ds_read_b64 v[154:155], v3 offset:1096
    ds_read_b128 v[92:95], v2 offset:2112
    v_mfma_f32_16x16x32_bf16 v[60:63], v[112:115], v[28:31], v[60:63]
    ds_read_b64 v[156:157], v3 offset:1600
    ds_read_b64 v[158:159], v3 offset:1608
    v_mfma_f32_16x16x32_bf16 v[64:67], v[124:127], v[20:23], v[64:67]
    ds_read_b128 v[96:99], v2 offset:1600
    v_mfma_f32_16x16x32_bf16 v[64:67], v[116:119], v[28:31], v[64:67]
    ds_read_b64 v[160:161], v3 offset:2112
    v_mfma_f32_16x16x32_bf16 v[64:67], v[128:131], v[16:19], v[64:67]
    ds_read_b64 v[162:163], v3 offset:2120
    v_mfma_f32_16x16x32_bf16 v[64:67], v[112:115], v[32:35], v[64:67]
    ds_read_b128 v[100:103], v2 offset:1088
    v_mfma_f32_16x16x32_bf16 v[68:71], v[128:131], v[28:31], v[68:71]
    ds_read_b64 v[164:165], v3 offset:2624
    v_mfma_f32_16x16x32_bf16 v[68:71], v[124:127], v[32:35], v[68:71]
    ds_read_b64 v[166:167], v3 offset:2632
    v_mfma_f32_16x16x32_bf16 v[68:71], v[132:135], v[24:27], v[68:71]
    ds_read_b128 v[104:107], v2 offset:576
    v_mfma_f32_16x16x32_bf16 v[68:71], v[120:123], v[36:39], v[68:71]
    ds_read_b64 v[168:169], v3 offset:3136
    v_mfma_f32_16x16x32_bf16 v[68:71], v[136:139], v[20:23], v[68:71]
    ds_read_b64 v[170:171], v3 offset:3144
    v_mfma_f32_16x16x32_bf16 v[68:71], v[116:119], v[40:43], v[68:71]
    ds_read_b128 v[108:111], v2 offset:64
    v_mfma_f32_16x16x32_bf16 v[68:71], v[140:143], v[16:19], v[68:71]
    ds_read_b64 v[172:173], v3 offset:3648
    v_mfma_f32_16x16x32_bf16 v[68:71], v[112:115], v[44:47], v[68:71]
    ds_read_b64 v[174:175], v3 offset:3656
    s_waitcnt lgkmcnt(0)
    v_mfma_f32_16x16x32_bf16 v[56:59], v[144:147], v[80:83], v[56:59]
    ds_read_b128 v[16:19], v2 offset:3712
    ds_read_b64 v[112:113], v3 offset:128
    v_mfma_f32_16x16x32_bf16 v[60:63], v[152:155], v[84:87], v[60:63]
    ds_read_b64 v[114:115], v3 offset:136
    ds_read_b128 v[20:23], v2 offset:3200
    v_mfma_f32_16x16x32_bf16 v[60:63], v[148:151], v[88:91], v[60:63]
    ds_read_b64 v[116:117], v3 offset:640
    ds_read_b64 v[118:119], v3 offset:648
    v_mfma_f32_16x16x32_bf16 v[64:67], v[152:155], v[88:91], v[64:67]
    ds_read_b128 v[24:27], v2 offset:2688
    ds_read_b64 v[120:121], v3 offset:1152
    v_mfma_f32_16x16x32_bf16 v[60:63], v[156:159], v[80:83], v[60:63]
    ds_read_b64 v[122:123], v3 offset:1160
    ds_read_b128 v[28:31], v2 offset:2176
    v_mfma_f32_16x16x32_bf16 v[60:63], v[144:147], v[92:95], v[60:63]
    ds_read_b64 v[124:125], v3 offset:1664
    ds_read_b64 v[126:127], v3 offset:1672
    v_mfma_f32_16x16x32_bf16 v[64:67], v[156:159], v[84:87], v[64:67]
    ds_read_b128 v[32:35], v2 offset:1664
    v_mfma_f32_16x16x32_bf16 v[64:67], v[148:151], v[92:95], v[64:67]
    ds_read_b64 v[128:129], v3 offset:2176
    v_mfma_f32_16x16x32_bf16 v[64:67], v[160:163], v[80:83], v[64:67]
    ds_read_b64 v[130:131], v3 offset:2184
    v_mfma_f32_16x16x32_bf16 v[64:67], v[144:147], v[96:99], v[64:67]
    ds_read_b128 v[36:39], v2 offset:1152
    v_mfma_f32_16x16x32_bf16 v[68:71], v[160:163], v[92:95], v[68:71]
    ds_read_b64 v[132:133], v3 offset:2688
    v_mfma_f32_16x16x32_bf16 v[68:71], v[156:159], v[96:99], v[68:71]
    ds_read_b64 v[134:135], v3 offset:2696
    v_mfma_f32_16x16x32_bf16 v[68:71], v[164:167], v[88:91], v[68:71]
    ds_read_b128 v[40:43], v2 offset:640
    v_mfma_f32_16x16x32_bf16 v[68:71], v[152:155], v[100:103], v[68:71]
    ds_read_b64 v[136:137], v3 offset:3200
    v_mfma_f32_16x16x32_bf16 v[68:71], v[168:171], v[84:87], v[68:71]
    ds_read_b64 v[138:139], v3 offset:3208
    v_mfma_f32_16x16x32_bf16 v[68:71], v[148:151], v[104:107], v[68:71]
    ds_read_b128 v[44:47], v2 offset:128
    v_mfma_f32_16x16x32_bf16 v[68:71], v[172:175], v[80:83], v[68:71]
    ds_read_b64 v[140:141], v3 offset:3712
    v_mfma_f32_16x16x32_bf16 v[68:71], v[144:147], v[108:111], v[68:71]
    ds_read_b64 v[142:143], v3 offset:3720
    v_add_u32 v2, 128, v2
    v_add_u32 v3, 128, v3
    s_add_u32 s78, s78, 1
    s_cmp_lt_u32 s78, 4
    s_cbranch_scc1 L_cl0
    s_waitcnt lgkmcnt(0)
    s_nop 7
    v_lshlrev_b32 v80, 16, v176
    v_and_b32 v81, 0xffff0000, v176
    v_lshlrev_b32 v82, 16, v177
    v_and_b32 v83, 0xffff0000, v177
    v_lshlrev_b32 v84, 16, v178
    v_and_b32 v85, 0xffff0000, v178
    v_lshlrev_b32 v86, 16, v179
    v_and_b32 v87, 0xffff0000, v179
    v_lshlrev_b32 v88, 16, v180
    v_and_b32 v89, 0xffff0000, v180
    v_lshlrev_b32 v90, 16, v181
    v_and_b32 v91, 0xffff0000, v181
    v_lshlrev_b32 v92, 16, v182
    v_and_b32 v93, 0xffff0000, v182
    v_lshlrev_b32 v94, 16, v183
    v_and_b32 v95, 0xffff0000, v183
    v_fmac_f32 v56, s75, v80
    v_fmac_f32 v57, s75, v81
    v_fmac_f32 v58, s75, v82
    v_fmac_f32 v59, s75, v83
    v_cvt_pk_bf16_f32 v16, v56, v57
    v_cvt_pk_bf16_f32 v17, v58, v59
    buffer_store_dwordx2 v[16:17], v8, s[12:15], s71 offen offset:0 sc1
    v_fmac_f32 v60, s75, v84
    v_fmac_f32 v61, s75, v85
    v_fmac_f32 v62, s75, v86
    v_fmac_f32 v63, s75, v87
    v_cvt_pk_bf16_f32 v18, v60, v61
    v_cvt_pk_bf16_f32 v19, v62, v63
    buffer_store_dwordx2 v[18:19], v8, s[12:15], s71 offen offset:1536 sc1
    v_fmac_f32 v64, s75, v88
    v_fmac_f32 v65, s75, v89
    v_fmac_f32 v66, s75, v90
    v_fmac_f32 v67, s75, v91
    v_cvt_pk_bf16_f32 v20, v64, v65
    v_cvt_pk_bf16_f32 v21, v66, v67
    buffer_store_dwordx2 v[20:21], v8, s[12:15], s71 offen offset:2048 sc1
    v_fmac_f32 v68, s75, v92
    v_fmac_f32 v69, s75, v93
    v_fmac_f32 v70, s75, v94
    v_fmac_f32 v71, s75, v95
    v_cvt_pk_bf16_f32 v22, v68, v69
    v_cvt_pk_bf16_f32 v23, v70, v71
    buffer_store_dwordx2 v[22:23], v8, s[12:15], s71 offen offset:3584 sc1
    s_branch L_conv_done
L_conv1:
    s_nop 1
    ds_read_b64 v[176:177], v72 offset:512
    ds_read_b64 v[178:179], v72 offset:1024
    ds_read_b64 v[180:181], v72 offset:2560
    ds_read_b64 v[182:183], v72 offset:3072
    ds_read_b128 v[16:19], v2 offset:3584
    ds_read_b64 v[112:113], v3 offset:0
    ds_read_b64 v[114:115], v3 offset:8
    ds_read_b128 v[20:23], v2 offset:3072
    ds_read_b64 v[116:117], v3 offset:512
    ds_read_b64 v[118:119], v3 offset:520
    ds_read_b128 v[24:27], v2 offset:2560
    ds_read_b64 v[120:121], v3 offset:1024
    ds_read_b64 v[122:123], v3 offset:1032
    ds_read_b128 v[28:31], v2 offset:2048
    ds_read_b64 v[124:125], v3 offset:1536
    ds_read_b64 v[126:127], v3 offset:1544
    ds_read_b128 v[32:35], v2 offset:1536
    ds_read_b64 v[128:129], v3 offset:2048
    ds_read_b64 v[130:131], v3 offset:2056
    ds_read_b128 v[36:39], v2 offset:1024
    ds_read_b64 v[132:133], v3 offset:2560
    ds_read_b64 v[134:135], v3 offset:2568
    ds_read_b128 v[40:43], v2 offset:512
    ds_read_b64 v[136:137], v3 offset:3072
    ds_read_b64 v[138:139], v3 offset:3080
L_cl1:
    s_waitcnt lgkmcnt(0)
    v_mfma_f32_16x16x32_bf16 v[56:59], v[116:119], v[16:19], v[56:59]
    ds_read_b128 v[80:83], v2 offset:3648
    ds_read_b64 v[144:145], v3 offset:64
    v_mfma_f32_16x16x32_bf16 v[56:59], v[112:115], v[20:23], v[56:59]
    ds_read_b64 v[146:147], v3 offset:72
    ds_read_b128 v[84:87], v2 offset:3136
    v_mfma_f32_16x16x32_bf16 v[60:63], v[116:119], v[20:23], v[60:63]
    ds_read_b64 v[148:149], v3 offset:576
    ds_read_b64 v[150:151], v3 offset:584
    v_mfma_f32_16x16x32_bf16 v[60:63], v[120:123], v[16:19], v[60:63]
    ds_read_b128 v[88:91], v2 offset:2624
    v_mfma_f32_16x16x32_bf16 v[60:63], v[112:115], v[24:27], v[60:63]
    ds_read_b64 v[152:153], v3 offset:1088
    v_mfma_f32_16x16x32_bf16 v[64:67], v[124:127], v[24:27], v[64:67]
    ds_read_b64 v[154:155], v3 offset:1096
    v_mfma_f32_16x16x32_bf16 v[64:67], v[120:123], v[28:31], v[64:67]
    ds_read_b128 v[92:95], v2 offset:2112
    v_mfma_f32_16x16x32_bf16 v[68:71], v[124:127], v[28:31], v[68:71]
    ds_read_b64 v[156:157], v3 offset:1600
    v_mfma_f32_16x16x32_bf16 v[64:67], v[128:131], v[20:23], v[64:67]
    ds_read_b64 v[158:159], v3 offset:1608
    v_mfma_f32_16x16x32_bf16 v[64:67], v[116:119], v[32:35], v[64:67]
    ds_read_b128 v[96:99], v2 offset:1600
    v_mfma_f32_16x16x32_bf16 v[68:71], v[128:131], v[24:27], v[68:71]
    ds_read_b64 v[160:161], v3 offset:2112
    v_mfma_f32_16x16x32_bf16 v[68:71], v[120:123], v[32:35], v[68:71]
    ds_read_b64 v[162:163], v3 offset:2120
    v_mfma_f32_16x16x32_bf16 v[64:67], v[132:135], v[16:19], v[64:67]
    ds_read_b128 v[100:103], v2 offset:1088
    v_mfma_f32_16x16x32_bf16 v[64:67], v[112:115], v[36:39], v[64:67]
    ds_read_b64 v[164:165], v3 offset:2624
    v_mfma_f32_16x16x32_bf16 v[68:71], v[132:135], v[20:23], v[68:71]
    ds_read_b64 v[166:167], v3 offset:2632
    v_mfma_f32_16x16x32_bf16 v[68:71], v[116:119], v[36:39], v[68:71]
    ds_read_b128 v[104:107], v2 offset:576
    v_mfma_f32_16x16x32_bf16 v[68:71], v[136:139], v[16:19], v[68:71]
    ds_read_b64 v[168:169], v3 offset:3136
    v_mfma_f32_16x16x32_bf16 v[68:71], v[112:115], v[40:43], v[68:71]
    ds_read_b64 v[170:171], v3 offset:3144
    s_waitcnt lgkmcnt(0)
    v_mfma_f32_16x16x32_bf16 v[56:59], v[148:151], v[80:83], v[56:59]
    ds_read_b128 v[16:19], v2 offset:3712
    ds_read_b64 v[112:113], v3 offset:128
    v_mfma_f32_16x16x32_bf16 v[56:59], v[144:147], v[84:87], v[56:59]
    ds_read_b64 v[114:115], v3 offset:136
    ds_read_b128 v[20:23], v2 offset:3200
    v_mfma_f32_16x16x32_bf16 v[60:63], v[148:151], v[84:87], v[60:63]
    ds_read_b64 v[116:117], v3 offset:640
    ds_read_b64 v[118:119], v3 offset:648
    v_mfma_f32_16x16x32_bf16 v[60:63], v[152:155], v[80:83], v[60:63]
    ds_read_b128 v[24:27], v2 offset:2688
    v_mfma_f32_16x16x32_bf16 v[60:63], v[144:147], v[88:91], v[60:63]
    ds_read_b64 v[120:121], v3 offset:1152
    v_mfma_f32_16x16x32_bf16 v[64:67], v[156:159], v[88:91], v[64:67]
    ds_read_b64 v[122:123], v3 offset:1160
    v_mfma_f32_16x16x32_bf16 v[64:67], v[152:155], v[92:95], v[64:67]
    ds_read_b128 v[28:31], v2 offset:2176
    v_mfma_f32_16x16x32_bf16 v[68:71], v[156:159], v[92:95], v[68:71]
    ds_read_b64 v[124:125], v3 offset:1664
    v_mfma_f32_16x16x32_bf16 v[64:67], v[160:163], v[84:87], v[64:67]
    ds_read_b64 v[126:127], v3 offset:1672
    v_mfma_f32_16x16x32_bf16 v[64:67], v[148:151], v[96:99], v[64:67]
    ds_read_b128 v[32:35], v2 offset:1664
    v_mfma_f32_16x16x32_bf16 v[68:71], v[160:163], v[88:91], v[68:71]
    ds_read_b64 v[128:129], v3 offset:2176
    v_mfma_f32_16x16x32_bf16 v[68:71], v[152:155], v[96:99], v[68:71]
    ds_read_b64 v[130:131], v3 offset:2184
    v_mfma_f32_16x16x32_bf16 v[64:67], v[164:167], v[80:83], v[64:67]
    ds_read_b128 v[36:39], v2 offset:1152
    v_mfma_f32_16x16x32_bf16 v[64:67], v[144:147], v[100:103], v[64:67]
    ds_read_b64 v[132:133], v3 offset:2688
    v_mfma_f32_16x16x32_bf16 v[68:71], v[164:167], v[84:87], v[68:71]
    ds_read_b64 v[134:135], v3 offset:2696
    v_mfma_f32_16x16x32_bf16 v[68:71], v[148:151], v[100:103], v[68:71]
    ds_read_b128 v[40:43], v2 offset:640
    v_mfma_f32_16x16x32_bf16 v[68:71], v[168:171], v[80:83], v[68:71]
    ds_read_b64 v[136:137], v3 offset:3200
    v_mfma_f32_16x16x32_bf16 v[68:71], v[144:147], v[104:107], v[68:71]
    ds_read_b64 v[138:139], v3 offset:3208
    v_add_u32 v2, 128, v2
    v_add_u32 v3, 128, v3
    s_add_u32 s78, s78, 1
    s_cmp_lt_u32 s78, 4
    s_cbranch_scc1 L_cl1
    s_waitcnt lgkmcnt(0)
    s_nop 7
    v_lshlrev_b32 v80, 16, v176
    v_and_b32 v81, 0xffff0000, v176
    v_lshlrev_b32 v82, 16, v177
    v_and_b32 v83, 0xffff0000, v177
    v_lshlrev_b32 v84, 16, v178
    v_and_b32 v85, 0xffff0000, v178
    v_lshlrev_b32 v86, 16, v179
    v_and_b32 v87, 0xffff0000, v179
    v_lshlrev_b32 v88, 16, v180
    v_and_b32 v89, 0xffff0000, v180
    v_lshlrev_b32 v90, 16, v181
    v_and_b32 v91, 0xffff0000, v181
    v_lshlrev_b32 v92, 16, v182
    v_and_b32 v93, 0xffff0000, v182
    v_lshlrev_b32 v94, 16, v183
    v_and_b32 v95, 0xffff0000, v183
    v_fmac_f32 v56, s75, v80
    v_fmac_f32 v57, s75, v81
    v_fmac_f32 v58, s75, v82
    v_fmac_f32 v59, s75, v83
    v_cvt_pk_bf16_f32 v16, v56, v57
    v_cvt_pk_bf16_f32 v17, v58, v59
    buffer_store_dwordx2 v[16:17], v8, s[12:15], s71 offen offset:512 sc1
    v_fmac_f32 v60, s75, v84
    v_fmac_f32 v61, s75, v85
    v_fmac_f32 v62, s75, v86
    v_fmac_f32 v63, s75, v87
    v_cvt_pk_bf16_f32 v18, v60, v61
    v_cvt_pk_bf16_f32 v19, v62, v63
    buffer_store_dwordx2 v[18:19], v8, s[12:15], s71 offen offset:1024 sc1
    v_fmac_f32 v64, s75, v88
    v_fmac_f32 v65, s75, v89
    v_fmac_f32 v66, s75, v90
    v_fmac_f32 v67, s75, v91
    v_cvt_pk_bf16_f32 v20, v64, v65
    v_cvt_pk_bf16_f32 v21, v66, v67
    buffer_store_dwordx2 v[20:21], v8, s[12:15], s71 offen offset:2560 sc1
    v_fmac_f32 v68, s75, v92
    v_fmac_f32 v69, s75, v93
    v_fmac_f32 v70, s75, v94
    v_fmac_f32 v71, s75, v95
    v_cvt_pk_bf16_f32 v22, v68, v69
    v_cvt_pk_bf16_f32 v23, v70, v71
    buffer_store_dwordx2 v[22:23], v8, s[12:15], s71 offen offset:3072 sc1
L_conv_done:
    s_waitcnt vmcnt(0)
    s_barrier
    s_cmp_lg_u32 s70, 0
    s_cbranch_scc1 L_s_end
    v_cmp_ne_u32 vcc, s87, v14
    s_nop 4
    s_cbranch_vccz L_wfd11
    s_mov_b32 s78, 0
L_wf11:
    s_sleep 4
    buffer_load_dword v14, v11, s[88:91], 0 offen sc1
    s_add_u32 s78, s78, 1
    s_waitcnt vmcnt(0)
    v_cmp_ne_u32 vcc, s87, v14
    s_nop 4
    s_cbranch_vccz L_wfd11
    s_cmp_lt_u32 s78, 0x4000
    s_cbranch_scc1 L_wf11
L_wfd11:
    s_nop 0
    v_mov_b32 v40, 0
    v_mov_b32 v41, 0
    v_mov_b32 v42, 0
    v_mov_b32 v43, 0
    v_lshlrev_b32 v10, 4, v0
    v_and_b32 v9, 56, v0
    v_lshl_add_u32 v10, v9, 20, v10
    v_mov_b32 v40, s87
    buffer_store_dwordx4 v[40:43], v10, s[88:91], s100 offen sc1
L_s_end:
    s_endpgm
L_P:
    s_nop 1
    s_sub_u32 s101, s2, 224
    s_waitcnt lgkmcnt(0)
    s_add_u32 s88, s68, 11026432
    s_addc_u32 s89, s69, 0
    s_mov_b32 s90, 294912
    s_mov_b32 s91, 0x20000
    s_mov_b32 s92, s66
    s_mov_b32 s93, s67
    s_mov_b32 s94, 256
    s_mov_b32 s95, 0x20000
    s_mov_b32 s8, s36
    s_mov_b32 s9, s37
    s_mov_b32 s10, 1835008
    s_mov_b32 s11, 0x20000
    s_mov_b32 s12, s60
    s_mov_b32 s13, s61
    s_mov_b32 s14, 1605632
    s_mov_b32 s15, 0x20000
    s_mov_b32 s24, s62
    s_mov_b32 s25, s63
    s_mov_b32 s26, 896
    s_mov_b32 s27, 0x20000
    s_and_b32 s77, s101, 7
    s_lshl_b32 s77, s77, 2
    s_lshr_b32 s78, s101, 3
    s_add_u32 s84, s77, s78
    s_lshl_b32 s80, s78, 2
    s_add_u32 s80, s80, s70
    s_lshl_b32 s80, s80, 10
    s_and_b32 s82, s101, 7
    s_mul_i32 s82, s82, 200704
    s_and_b32 s82, s82, 0xffffc000
    s_add_u32 s81, s80, s82
    v_lshlrev_b32 v2, 4, v0
    s_mul_i32 s77, s84, 57344
    s_mul_i32 s79, s70, 14336
    s_add_u32 s77, s77, s79
    s_add_u32 m0, s79, 0
    s_add_u32 s78, s77, 0
    buffer_load_dwordx4 v2, s[8:11], s78 offen offset:0 lds
    buffer_load_dwordx4 v2, s[8:11], s78 offen offset:1024 lds
    buffer_load_dwordx4 v2, s[8:11], s78 offen offset:2048 lds
    buffer_load_dwordx4 v2, s[8:11], s78 offen offset:3072 lds
    s_add_u32 m0, s79, 4096
    s_add_u32 s78, s77, 4096
    buffer_load_dwordx4 v2, s[8:11], s78 offen offset:0 lds
    buffer_load_dwordx4 v2, s[8:11], s78 offen offset:1024 lds
    buffer_load_dwordx4 v2, s[8:11], s78 offen offset:2048 lds
    buffer_load_dwordx4 v2, s[8:11], s78 offen offset:3072 lds
    s_add_u32 m0, s79, 8192
    s_add_u32 s78, s77, 8192
    buffer_load_dwordx4 v2, s[8:11], s78 offen offset:0 lds
    buffer_load_dwordx4 v2, s[8:11], s78 offen offset:1024 lds
    buffer_load_dwordx4 v2, s[8:11], s78 offen offset:2048 lds
    buffer_load_dwordx4 v2, s[8:11], s78 offen offset:3072 lds
    s_add_u32 m0, s79, 12288
    s_add_u32 s78, s77, 12288
    buffer_load_dwordx4 v2, s[8:11], s78 offen offset:0 lds
    buffer_load_dwordx4 v2, s[8:11], s78 offen offset:1024 lds
    v_and_b32 v3, 3, v0
    v_mul_u32_u24 v3, 224, v3
    buffer_load_dwordx4 v[64:67], v3, s[24:27], 0 offen offset:0
    buffer_load_dwordx4 v[68:71], v3, s[24:27], 0 offen offset:16
    buffer_load_dwordx4 v[72:75], v3, s[24:27], 0 offen offset:32
    buffer_load_dwordx4 v[76:79], v3, s[24:27], 0 offen offset:48
    buffer_load_dwordx4 v[80:83], v3, s[24:27], 0 offen offset:64
    buffer_load_dwordx4 v[84:87], v3, s[24:27], 0 offen offset:80
    buffer_load_dwordx4 v[88:91], v3, s[24:27], 0 offen offset:96
    buffer_load_dwordx4 v[92:95], v3, s[24:27], 0 offen offset:112
    buffer_load_dwordx4 v[96:99], v3, s[24:27], 0 offen offset:128
    buffer_load_dwordx4 v[100:103], v3, s[24:27], 0 offen offset:144
    buffer_load_dwordx4 v[104:107], v3, s[24:27], 0 offen offset:160
    buffer_load_dwordx4 v[108:111], v3, s[24:27], 0 offen offset:176
    buffer_load_dwordx4 v[112:115], v3, s[24:27], 0 offen offset:192
    buffer_load_dwordx4 v[116:119], v3, s[24:27], 0 offen offset:208
    v_mov_b32 v12, 0
    buffer_load_dword v13, v12, s[92:95], 0 offen sc1
    s_add_u32 s16, s68, 7340032
    s_addc_u32 s17, s69, 0
    s_mov_b32 s18, 1835008
    s_mov_b32 s19, 0x20000
    s_add_u32 s20, s68, 11010048
    s_addc_u32 s21, s69, 0
    s_mov_b32 s22, 16384
    s_mov_b32 s23, 0x20000
    v_lshrrev_b32 v16, 4, v0
    v_lshrrev_b32 v17, 2, v0
    v_and_b32 v17, 3, v17
    v_lshl_add_u32 v17, v16, 4, v17
    v_mul_u32_u24 v17, 896, v17
    v_and_b32 v18, 3, v0
    v_lshl_add_u32 v17, v18, 3, v17
    s_mul_i32 s77, s70, 224
    v_add_u32 v17, s77, v17
    v_lshrrev_b32 v19, 2, v0
    v_mul_u32_u24 v19, 896, v19
    v_add_u32 v19, v19, v3
    s_mul_i32 s77, s70, 14336
    v_add_u32 v19, s77, v19
    v_and_b32 v20, 15, v0
    v_mul_u32_u24 v20, 144, v20
    v_lshl_add_u32 v20, v16, 5, v20
    v_lshrrev_b32 v22, 3, v0
    v_and_b32 v23, 7, v0
    v_mul_u32_u24 v50, 144, v22
    v_lshl_add_u32 v50, v23, 4, v50
    v_lshlrev_b32 v51, 12, v22
    v_lshl_add_u32 v51, v23, 4, v51
    s_mul_i32 s77, s70, 4608
    s_add_u32 s77, s77, 57344
    v_add_u32 v20, s77, v20
    v_add_u32 v50, s77, v50
    s_mul_i32 s79, s70, 458752
    s_lshl_b32 s78, s84, 7
    s_add_u32 s79, s79, s78
    s_waitcnt vmcnt(0)
    s_barrier
    ds_read_b64_tr_b16 v[128:129], v17 offset:0
    ds_read_b64_tr_b16 v[130:131], v17 offset:3584
    ds_read_b64_tr_b16 v[132:133], v17 offset:7168
    ds_read_b64_tr_b16 v[134:135], v17 offset:10752
    ds_read_b64_tr_b16 v[136:137], v17 offset:32
    ds_read_b64_tr_b16 v[138:139], v17 offset:3616
    ds_read_b64_tr_b16 v[140:141], v17 offset:7200
    ds_read_b64_tr_b16 v[142:143], v17 offset:10784
    ds_read_b64_tr_b16 v[144:145], v17 offset:64
    ds_read_b64_tr_b16 v[146:147], v17 offset:3648
    ds_read_b64_tr_b16 v[148:149], v17 offset:7232
    ds_read_b64_tr_b16 v[150:151], v17 offset:10816
    s_waitcnt lgkmcnt(4)
    ds_read_b64_tr_b16 v[152:153], v17 offset:96
    ds_read_b64_tr_b16 v[154:155], v17 offset:3680
    ds_read_b64_tr_b16 v[156:157], v17 offset:7264
    ds_read_b64_tr_b16 v[158:159], v17 offset:10848
    ds_read_b64_tr_b16 v[160:161], v17 offset:128
    ds_read_b64_tr_b16 v[162:163], v17 offset:3712
    ds_read_b64_tr_b16 v[164:165], v17 offset:7296
    ds_read_b64_tr_b16 v[166:167], v17 offset:10880
    ds_read_b64_tr_b16 v[168:169], v17 offset:160
    ds_read_b64_tr_b16 v[170:171], v17 offset:3744
    ds_read_b64_tr_b16 v[172:173], v17 offset:7328
    ds_read_b64_tr_b16 v[174:175], v17 offset:10912
    s_waitcnt lgkmcnt(4)
    ds_read_b64_tr_b16 v[176:177], v17 offset:192
    ds_read_b64_tr_b16 v[178:179], v17 offset:3776
    ds_read_b64_tr_b16 v[180:181], v17 offset:7360
    ds_read_b64_tr_b16 v[182:183], v17 offset:10944
    s_waitcnt lgkmcnt(0)
    ds_write_b128 v20, v[128:131] offset:0
    ds_write_b128 v20, v[132:135] offset:16
    ds_write_b128 v20, v[136:139] offset:2304
    ds_write_b128 v20, v[140:143] offset:2320
    ds_read_b128 v[192:195], v50 offset:0
    ds_read_b128 v[196:199], v50 offset:1152
    ds_read_b128 v[200:203], v50 offset:2304
    ds_read_b128 v[204:207], v50 offset:3456
    s_waitcnt lgkmcnt(0)
    s_add_u32 s77, s79, 0
    buffer_store_dwordx4 v[192:195], v51, s[16:19], s77 offen sc1
    s_add_u32 s77, s79, 32768
    buffer_store_dwordx4 v[196:199], v51, s[16:19], s77 offen sc1
    s_add_u32 s77, s79, 65536
    buffer_store_dwordx4 v[200:203], v51, s[16:19], s77 offen sc1
    s_add_u32 s77, s79, 98304
    buffer_store_dwordx4 v[204:207], v51, s[16:19], s77 offen sc1
    ds_write_b128 v20, v[144:147] offset:0
    ds_write_b128 v20, v[148:151] offset:16
    ds_write_b128 v20, v[152:155] offset:2304
    ds_write_b128 v20, v[156:159] offset:2320
    ds_read_b128 v[208:211], v50 offset:0
    ds_read_b128 v[212:215], v50 offset:1152
    ds_read_b128 v[216:219], v50 offset:2304
    ds_read_b128 v[220:223], v50 offset:3456
    s_waitcnt lgkmcnt(0)
    s_add_u32 s77, s79, 131072
    buffer_store_dwordx4 v[208:211], v51, s[16:19], s77 offen sc1
    s_add_u32 s77, s79, 163840
    buffer_store_dwordx4 v[212:215], v51, s[16:19], s77 offen sc1
    s_add_u32 s77, s79, 196608
    buffer_store_dwordx4 v[216:219], v51, s[16:19], s77 offen sc1
    s_add_u32 s77, s79, 229376
    buffer_store_dwordx4 v[220:223], v51, s[16:19], s77 offen sc1
    ds_write_b128 v20, v[160:163] offset:0
    ds_write_b128 v20, v[164:167] offset:16
    ds_write_b128 v20, v[168:171] offset:2304
    ds_write_b128 v20, v[172:175] offset:2320
    ds_read_b128 v[224:227], v50 offset:0
    ds_read_b128 v[228:231], v50 offset:1152
    ds_read_b128 v[232:235], v50 offset:2304
    ds_read_b128 v[236:239], v50 offset:3456
    s_waitcnt lgkmcnt(0)
    s_add_u32 s77, s79, 262144
    buffer_store_dwordx4 v[224:227], v51, s[16:19], s77 offen sc1
    s_add_u32 s77, s79, 294912
    buffer_store_dwordx4 v[228:231], v51, s[16:19], s77 offen sc1
    s_add_u32 s77, s79, 327680
    buffer_store_dwordx4 v[232:235], v51, s[16:19], s77 offen sc1
    s_add_u32 s77, s79, 360448
    buffer_store_dwordx4 v[236:239], v51, s[16:19], s77 offen sc1
    ds_write_b128 v20, v[176:179] offset:0
    ds_write_b128 v20, v[180:183] offset:16
    ds_read_b128 v[240:243], v50 offset:0
    ds_read_b128 v[244:247], v50 offset:1152
    s_waitcnt lgkmcnt(0)
    s_add_u32 s77, s79, 393216
    buffer_store_dwordx4 v[240:243], v51, s[16:19], s77 offen sc1
    s_add_u32 s77, s79, 425984
    buffer_store_dwordx4 v[244:247], v51, s[16:19], s77 offen sc1
    v_readfirstlane_b32 s87, v13
    s_nop 0
    s_cmp_lg_u32 s87, 0
    s_cbranch_scc1 L_gnd12
    s_mov_b32 s78, 0
L_gn12:
    buffer_load_dword v13, v12, s[92:95], 0 offen sc1
    s_waitcnt vmcnt(0)
    v_readfirstlane_b32 s87, v13
    s_add_u32 s78, s78, 1
    s_cmp_lg_u32 s87, 0
    s_cbranch_scc1 L_gnd12
    s_sleep 8
    s_cmp_lt_u32 s78, 0x2000
    s_cbranch_scc1 L_gn12
L_gnd12:
    s_nop 0
    s_lshl_b32 s100, s84, 7
    s_add_u32 s100, s100, 229376
    v_mov_b32 v48, 0
    v_mov_b32 v49, 0
    ds_read_b128 v[24:27], v19
    ds_read_b128 v[28:31], v19 offset:16
    s_waitcnt lgkmcnt(1)
    v_lshlrev_b32 v32, 16, v24
    v_and_b32 v33, 0xffff0000, v24
    v_lshlrev_b32 v40, 16, v64
    v_and_b32 v41, 0xffff0000, v64
    v_lshlrev_b32 v34, 16, v25
    v_and_b32 v35, 0xffff0000, v25
    v_lshlrev_b32 v42, 16, v65
    v_and_b32 v43, 0xffff0000, v65
    v_lshlrev_b32 v36, 16, v26
    v_and_b32 v37, 0xffff0000, v26
    v_lshlrev_b32 v44, 16, v66
    v_and_b32 v45, 0xffff0000, v66
    v_lshlrev_b32 v38, 16, v27
    v_and_b32 v39, 0xffff0000, v27
    v_lshlrev_b32 v46, 16, v67
    v_and_b32 v47, 0xffff0000, v67
    v_pk_mul_f32 v[32:33], v[32:33], v[40:41]
    v_pk_mul_f32 v[34:35], v[34:35], v[42:43]
    v_pk_mul_f32 v[36:37], v[36:37], v[44:45]
    v_pk_mul_f32 v[38:39], v[38:39], v[46:47]
    v_cvt_pk_bf16_f32 v40, v32, v33
    v_cvt_pk_bf16_f32 v41, v34, v35
    v_cvt_pk_bf16_f32 v42, v36, v37
    v_cvt_pk_bf16_f32 v43, v38, v39
    v_lshlrev_b32 v32, 16, v40
    v_and_b32 v33, 0xffff0000, v40
    v_lshlrev_b32 v34, 16, v41
    v_and_b32 v35, 0xffff0000, v41
    v_lshlrev_b32 v36, 16, v42
    v_and_b32 v37, 0xffff0000, v42
    v_lshlrev_b32 v38, 16, v43
    v_and_b32 v39, 0xffff0000, v43
    v_pk_add_f32 v[32:33], v[32:33], v[34:35]
    v_pk_add_f32 v[36:37], v[36:37], v[38:39]
    v_pk_add_f32 v[48:49], v[48:49], v[32:33]
    v_pk_add_f32 v[48:49], v[48:49], v[36:37]
    ds_read_b128 v[24:27], v19 offset:32
    s_waitcnt lgkmcnt(1)
    v_lshlrev_b32 v32, 16, v28
    v_and_b32 v33, 0xffff0000, v28
    v_lshlrev_b32 v40, 16, v68
    v_and_b32 v41, 0xffff0000, v68
    v_lshlrev_b32 v34, 16, v29
    v_and_b32 v35, 0xffff0000, v29
    v_lshlrev_b32 v42, 16, v69
    v_and_b32 v43, 0xffff0000, v69
    v_lshlrev_b32 v36, 16, v30
    v_and_b32 v37, 0xffff0000, v30
    v_lshlrev_b32 v44, 16, v70
    v_and_b32 v45, 0xffff0000, v70
    v_lshlrev_b32 v38, 16, v31
    v_and_b32 v39, 0xffff0000, v31
    v_lshlrev_b32 v46, 16, v71
    v_and_b32 v47, 0xffff0000, v71
    v_pk_mul_f32 v[32:33], v[32:33], v[40:41]
    v_pk_mul_f32 v[34:35], v[34:35], v[42:43]
    v_pk_mul_f32 v[36:37], v[36:37], v[44:45]
    v_pk_mul_f32 v[38:39], v[38:39], v[46:47]
    v_cvt_pk_bf16_f32 v40, v32, v33
    v_cvt_pk_bf16_f32 v41, v34, v35
    v_cvt_pk_bf16_f32 v42, v36, v37
    v_cvt_pk_bf16_f32 v43, v38, v39
    v_lshlrev_b32 v32, 16, v40
    v_and_b32 v33, 0xffff0000, v40
    v_lshlrev_b32 v34, 16, v41
    v_and_b32 v35, 0xffff0000, v41
    v_lshlrev_b32 v36, 16, v42
    v_and_b32 v37, 0xffff0000, v42
    v_lshlrev_b32 v38, 16, v43
    v_and_b32 v39, 0xffff0000, v43
    v_pk_add_f32 v[32:33], v[32:33], v[34:35]
    v_pk_add_f32 v[36:37], v[36:37], v[38:39]
    v_pk_add_f32 v[48:49], v[48:49], v[32:33]
    v_pk_add_f32 v[48:49], v[48:49], v[36:37]
    ds_read_b128 v[28:31], v19 offset:48
    s_waitcnt lgkmcnt(1)
    v_lshlrev_b32 v32, 16, v24
    v_and_b32 v33, 0xffff0000, v24
    v_lshlrev_b32 v40, 16, v72
    v_and_b32 v41, 0xffff0000, v72
    v_lshlrev_b32 v34, 16, v25
    v_and_b32 v35, 0xffff0000, v25
    v_lshlrev_b32 v42, 16, v73
    v_and_b32 v43, 0xffff0000, v73
    v_lshlrev_b32 v36, 16, v26
    v_and_b32 v37, 0xffff0000, v26
    v_lshlrev_b32 v44, 16, v74
    v_and_b32 v45, 0xffff0000, v74
    v_lshlrev_b32 v38, 16, v27
    v_and_b32 v39, 0xffff0000, v27
    v_lshlrev_b32 v46, 16, v75
    v_and_b32 v47, 0xffff0000, v75
    v_pk_mul_f32 v[32:33], v[32:33], v[40:41]
    v_pk_mul_f32 v[34:35], v[34:35], v[42:43]
    v_pk_mul_f32 v[36:37], v[36:37], v[44:45]
    v_pk_mul_f32 v[38:39], v[38:39], v[46:47]
    v_cvt_pk_bf16_f32 v40, v32, v33
    v_cvt_pk_bf16_f32 v41, v34, v35
    v_cvt_pk_bf16_f32 v42, v36, v37
    v_cvt_pk_bf16_f32 v43, v38, v39
    v_lshlrev_b32 v32, 16, v40
    v_and_b32 v33, 0xffff0000, v40
    v_lshlrev_b32 v34, 16, v41
    v_and_b32 v35, 0xffff0000, v41
    v_lshlrev_b32 v36, 16, v42
    v_and_b32 v37, 0xffff0000, v42
    v_lshlrev_b32 v38, 16, v43
    v_and_b32 v39, 0xffff0000, v43
    v_pk_add_f32 v[32:33], v[32:33], v[34:35]
    v_pk_add_f32 v[36:37], v[36:37], v[38:39]
    v_pk_add_f32 v[48:49], v[48:49], v[32:33]
    v_pk_add_f32 v[48:49], v[48:49], v[36:37]
    ds_read_b128 v[24:27], v19 offset:64
    s_waitcnt lgkmcnt(1)
    v_lshlrev_b32 v32, 16, v28
    v_and_b32 v33, 0xffff0000, v28
    v_lshlrev_b32 v40, 16, v76
    v_and_b32 v41, 0xffff0000, v76
    v_lshlrev_b32 v34, 16, v29
    v_and_b32 v35, 0xffff0000, v29
    v_lshlrev_b32 v42, 16, v77
    v_and_b32 v43, 0xffff0000, v77
    v_lshlrev_b32 v36, 16, v30
    v_and_b32 v37, 0xffff0000, v30
    v_lshlrev_b32 v44, 16, v78
    v_and_b32 v45, 0xffff0000, v78
    v_lshlrev_b32 v38, 16, v31
    v_and_b32 v39, 0xffff0000, v31
    v_lshlrev_b32 v46, 16, v79
    v_and_b32 v47, 0xffff0000, v79
    v_pk_mul_f32 v[32:33], v[32:33], v[40:41]
    v_pk_mul_f32 v[34:35], v[34:35], v[42:43]
    v_pk_mul_f32 v[36:37], v[36:37], v[44:45]
    v_pk_mul_f32 v[38:39], v[38:39], v[46:47]
    v_cvt_pk_bf16_f32 v40, v32, v33
    v_cvt_pk_bf16_f32 v41, v34, v35
    v_cvt_pk_bf16_f32 v42, v36, v37
    v_cvt_pk_bf16_f32 v43, v38, v39
    v_lshlrev_b32 v32, 16, v40
    v_and_b32 v33, 0xffff0000, v40
    v_lshlrev_b32 v34, 16, v41
    v_and_b32 v35, 0xffff0000, v41
    v_lshlrev_b32 v36, 16, v42
    v_and_b32 v37, 0xffff0000, v42
    v_lshlrev_b32 v38, 16, v43
    v_and_b32 v39, 0xffff0000, v43
    v_pk_add_f32 v[32:33], v[32:33], v[34:35]
    v_pk_add_f32 v[36:37], v[36:37], v[38:39]
    v_pk_add_f32 v[48:49], v[48:49], v[32:33]
    v_pk_add_f32 v[48:49], v[48:49], v[36:37]
    s_waitcnt vmcnt(0)
    s_barrier
    s_cmp_lg_u32 s70, 0
    s_cbranch_scc1 L_P3a
    v_mov_b32 v52, 0
    v_mov_b32 v53, 0
    v_mov_b32 v54, 0
    v_mov_b32 v55, 0
    v_lshlrev_b32 v13, 4, v0
    v_and_b32 v12, 56, v0
    v_lshl_add_u32 v13, v12, 20, v13
    v_mov_b32 v52, s87
    buffer_store_dwordx4 v[52:55], v13, s[88:91], s100 offen sc1
L_P3a:
    s_nop 0
    ds_read_b128 v[28:31], v19 offset:80
    s_waitcnt lgkmcnt(1)
    v_lshlrev_b32 v32, 16, v24
    v_and_b32 v33, 0xffff0000, v24
    v_lshlrev_b32 v40, 16, v80
    v_and_b32 v41, 0xffff0000, v80
    v_lshlrev_b32 v34, 16, v25
    v_and_b32 v35, 0xffff0000, v25
    v_lshlrev_b32 v42, 16, v81
    v_and_b32 v43, 0xffff0000, v81
    v_lshlrev_b32 v36, 16, v26
    v_and_b32 v37, 0xffff0000, v26
    v_lshlrev_b32 v44, 16, v82
    v_and_b32 v45, 0xffff0000, v82
    v_lshlrev_b32 v38, 16, v27
    v_and_b32 v39, 0xffff0000, v27
    v_lshlrev_b32 v46, 16, v83
    v_and_b32 v47, 0xffff0000, v83
    v_pk_mul_f32 v[32:33], v[32:33], v[40:41]
    v_pk_mul_f32 v[34:35], v[34:35], v[42:43]
    v_pk_mul_f32 v[36:37], v[36:37], v[44:45]
    v_pk_mul_f32 v[38:39], v[38:39], v[46:47]
    v_cvt_pk_bf16_f32 v40, v32, v33
    v_cvt_pk_bf16_f32 v41, v34, v35
    v_cvt_pk_bf16_f32 v42, v36, v37
    v_cvt_pk_bf16_f32 v43, v38, v39
    v_lshlrev_b32 v32, 16, v40
    v_and_b32 v33, 0xffff0000, v40
    v_lshlrev_b32 v34, 16, v41
    v_and_b32 v35, 0xffff0000, v41
    v_lshlrev_b32 v36, 16, v42
    v_and_b32 v37, 0xffff0000, v42
    v_lshlrev_b32 v38, 16, v43
    v_and_b32 v39, 0xffff0000, v43
    v_pk_add_f32 v[32:33], v[32:33], v[34:35]
    v_pk_add_f32 v[36:37], v[36:37], v[38:39]
    v_pk_add_f32 v[48:49], v[48:49], v[32:33]
    v_pk_add_f32 v[48:49], v[48:49], v[36:37]
    ds_read_b128 v[24:27], v19 offset:96
    s_waitcnt lgkmcnt(1)
    v_lshlrev_b32 v32, 16, v28
    v_and_b32 v33, 0xffff0000, v28
    v_lshlrev_b32 v40, 16, v84
    v_and_b32 v41, 0xffff0000, v84
    v_lshlrev_b32 v34, 16, v29
    v_and_b32 v35, 0xffff0000, v29
    v_lshlrev_b32 v42, 16, v85
    v_and_b32 v43, 0xffff0000, v85
    v_lshlrev_b32 v36, 16, v30
    v_and_b32 v37, 0xffff0000, v30
    v_lshlrev_b32 v44, 16, v86
    v_and_b32 v45, 0xffff0000, v86
    v_lshlrev_b32 v38, 16, v31
    v_and_b32 v39, 0xffff0000, v31
    v_lshlrev_b32 v46, 16, v87
    v_and_b32 v47, 0xffff0000, v87
    v_pk_mul_f32 v[32:33], v[32:33], v[40:41]
    v_pk_mul_f32 v[34:35], v[34:35], v[42:43]
    v_pk_mul_f32 v[36:37], v[36:37], v[44:45]
    v_pk_mul_f32 v[38:39], v[38:39], v[46:47]
    v_cvt_pk_bf16_f32 v40, v32, v33
    v_cvt_pk_bf16_f32 v41, v34, v35
    v_cvt_pk_bf16_f32 v42, v36, v37
    v_cvt_pk_bf16_f32 v43, v38, v39
    v_lshlrev_b32 v32, 16, v40
    v_and_b32 v33, 0xffff0000, v40
    v_lshlrev_b32 v34, 16, v41
    v_and_b32 v35, 0xffff0000, v41
    v_lshlrev_b32 v36, 16, v42
    v_and_b32 v37, 0xffff0000, v42
    v_lshlrev_b32 v38, 16, v43
    v_and_b32 v39, 0xffff0000, v43
    v_pk_add_f32 v[32:33], v[32:33], v[34:35]
    v_pk_add_f32 v[36:37], v[36:37], v[38:39]
    v_pk_add_f32 v[48:49], v[48:49], v[32:33]
    v_pk_add_f32 v[48:49], v[48:49], v[36:37]
    ds_read_b128 v[28:31], v19 offset:112
    s_waitcnt lgkmcnt(1)
    v_lshlrev_b32 v32, 16, v24
    v_and_b32 v33, 0xffff0000, v24
    v_lshlrev_b32 v40, 16, v88
    v_and_b32 v41, 0xffff0000, v88
    v_lshlrev_b32 v34, 16, v25
    v_and_b32 v35, 0xffff0000, v25
    v_lshlrev_b32 v42, 16, v89
    v_and_b32 v43, 0xffff0000, v89
    v_lshlrev_b32 v36, 16, v26
    v_and_b32 v37, 0xffff0000, v26
    v_lshlrev_b32 v44, 16, v90
    v_and_b32 v45, 0xffff0000, v90
    v_lshlrev_b32 v38, 16, v27
    v_and_b32 v39, 0xffff0000, v27
    v_lshlrev_b32 v46, 16, v91
    v_and_b32 v47, 0xffff0000, v91
    v_pk_mul_f32 v[32:33], v[32:33], v[40:41]
    v_pk_mul_f32 v[34:35], v[34:35], v[42:43]
    v_pk_mul_f32 v[36:37], v[36:37], v[44:45]
    v_pk_mul_f32 v[38:39], v[38:39], v[46:47]
    v_cvt_pk_bf16_f32 v40, v32, v33
    v_cvt_pk_bf16_f32 v41, v34, v35
    v_cvt_pk_bf16_f32 v42, v36, v37
    v_cvt_pk_bf16_f32 v43, v38, v39
    v_lshlrev_b32 v32, 16, v40
    v_and_b32 v33, 0xffff0000, v40
    v_lshlrev_b32 v34, 16, v41
    v_and_b32 v35, 0xffff0000, v41
    v_lshlrev_b32 v36, 16, v42
    v_and_b32 v37, 0xffff0000, v42
    v_lshlrev_b32 v38, 16, v43
    v_and_b32 v39, 0xffff0000, v43
    v_pk_add_f32 v[32:33], v[32:33], v[34:35]
    v_pk_add_f32 v[36:37], v[36:37], v[38:39]
    v_pk_add_f32 v[48:49], v[48:49], v[32:33]
    v_pk_add_f32 v[48:49], v[48:49], v[36:37]
    ds_read_b128 v[24:27], v19 offset:128
    s_waitcnt lgkmcnt(1)
    v_lshlrev_b32 v32, 16, v28
    v_and_b32 v33, 0xffff0000, v28
    v_lshlrev_b32 v40, 16, v92
    v_and_b32 v41, 0xffff0000, v92
    v_lshlrev_b32 v34, 16, v29
    v_and_b32 v35, 0xffff0000, v29
    v_lshlrev_b32 v42, 16, v93
    v_and_b32 v43, 0xffff0000, v93
    v_lshlrev_b32 v36, 16, v30
    v_and_b32 v37, 0xffff0000, v30
    v_lshlrev_b32 v44, 16, v94
    v_and_b32 v45, 0xffff0000, v94
    v_lshlrev_b32 v38, 16, v31
    v_and_b32 v39, 0xffff0000, v31
    v_lshlrev_b32 v46, 16, v95
    v_and_b32 v47, 0xffff0000, v95
    v_pk_mul_f32 v[32:33], v[32:33], v[40:41]
    v_pk_mul_f32 v[34:35], v[34:35], v[42:43]
    v_pk_mul_f32 v[36:37], v[36:37], v[44:45]
    v_pk_mul_f32 v[38:39], v[38:39], v[46:47]
    v_cvt_pk_bf16_f32 v40, v32, v33
    v_cvt_pk_bf16_f32 v41, v34, v35
    v_cvt_pk_bf16_f32 v42, v36, v37
    v_cvt_pk_bf16_f32 v43, v38, v39
    v_lshlrev_b32 v32, 16, v40
    v_and_b32 v33, 0xffff0000, v40
    v_lshlrev_b32 v34, 16, v41
    v_and_b32 v35, 0xffff0000, v41
    v_lshlrev_b32 v36, 16, v42
    v_and_b32 v37, 0xffff0000, v42
    v_lshlrev_b32 v38, 16, v43
    v_and_b32 v39, 0xffff0000, v43
    v_pk_add_f32 v[32:33], v[32:33], v[34:35]
    v_pk_add_f32 v[36:37], v[36:37], v[38:39]
    v_pk_add_f32 v[48:49], v[48:49], v[32:33]
    v_pk_add_f32 v[48:49], v[48:49], v[36:37]
    ds_read_b128 v[28:31], v19 offset:144
    s_waitcnt lgkmcnt(1)
    v_lshlrev_b32 v32, 16, v24
    v_and_b32 v33, 0xffff0000, v24
    v_lshlrev_b32 v40, 16, v96
    v_and_b32 v41, 0xffff0000, v96
    v_lshlrev_b32 v34, 16, v25
    v_and_b32 v35, 0xffff0000, v25
    v_lshlrev_b32 v42, 16, v97
    v_and_b32 v43, 0xffff0000, v97
    v_lshlrev_b32 v36, 16, v26
    v_and_b32 v37, 0xffff0000, v26
    v_lshlrev_b32 v44, 16, v98
    v_and_b32 v45, 0xffff0000, v98
    v_lshlrev_b32 v38, 16, v27
    v_and_b32 v39, 0xffff0000, v27
    v_lshlrev_b32 v46, 16, v99
    v_and_b32 v47, 0xffff0000, v99
    v_pk_mul_f32 v[32:33], v[32:33], v[40:41]
    v_pk_mul_f32 v[34:35], v[34:35], v[42:43]
    v_pk_mul_f32 v[36:37], v[36:37], v[44:45]
    v_pk_mul_f32 v[38:39], v[38:39], v[46:47]
    v_cvt_pk_bf16_f32 v40, v32, v33
    v_cvt_pk_bf16_f32 v41, v34, v35
    v_cvt_pk_bf16_f32 v42, v36, v37
    v_cvt_pk_bf16_f32 v43, v38, v39
    v_lshlrev_b32 v32, 16, v40
    v_and_b32 v33, 0xffff0000, v40
    v_lshlrev_b32 v34, 16, v41
    v_and_b32 v35, 0xffff0000, v41
    v_lshlrev_b32 v36, 16, v42
    v_and_b32 v37, 0xffff0000, v42
    v_lshlrev_b32 v38, 16, v43
    v_and_b32 v39, 0xffff0000, v43
    v_pk_add_f32 v[32:33], v[32:33], v[34:35]
    v_pk_add_f32 v[36:37], v[36:37], v[38:39]
    v_pk_add_f32 v[48:49], v[48:49], v[32:33]
    v_pk_add_f32 v[48:49], v[48:49], v[36:37]
    ds_read_b128 v[24:27], v19 offset:160
    s_waitcnt lgkmcnt(1)
    v_lshlrev_b32 v32, 16, v28
    v_and_b32 v33, 0xffff0000, v28
    v_lshlrev_b32 v40, 16, v100
    v_and_b32 v41, 0xffff0000, v100
    v_lshlrev_b32 v34, 16, v29
    v_and_b32 v35, 0xffff0000, v29
    v_lshlrev_b32 v42, 16, v101
    v_and_b32 v43, 0xffff0000, v101
    v_lshlrev_b32 v36, 16, v30
    v_and_b32 v37, 0xffff0000, v30
    v_lshlrev_b32 v44, 16, v102
    v_and_b32 v45, 0xffff0000, v102
    v_lshlrev_b32 v38, 16, v31
    v_and_b32 v39, 0xffff0000, v31
    v_lshlrev_b32 v46, 16, v103
    v_and_b32 v47, 0xffff0000, v103
    v_pk_mul_f32 v[32:33], v[32:33], v[40:41]
    v_pk_mul_f32 v[34:35], v[34:35], v[42:43]
    v_pk_mul_f32 v[36:37], v[36:37], v[44:45]
    v_pk_mul_f32 v[38:39], v[38:39], v[46:47]
    v_cvt_pk_bf16_f32 v40, v32, v33
    v_cvt_pk_bf16_f32 v41, v34, v35
    v_cvt_pk_bf16_f32 v42, v36, v37
    v_cvt_pk_bf16_f32 v43, v38, v39
    v_lshlrev_b32 v32, 16, v40
    v_and_b32 v33, 0xffff0000, v40
    v_lshlrev_b32 v34, 16, v41
    v_and_b32 v35, 0xffff0000, v41
    v_lshlrev_b32 v36, 16, v42
    v_and_b32 v37, 0xffff0000, v42
    v_lshlrev_b32 v38, 16, v43
    v_and_b32 v39, 0xffff0000, v43
    v_pk_add_f32 v[32:33], v[32:33], v[34:35]
    v_pk_add_f32 v[36:37], v[36:37], v[38:39]
    v_pk_add_f32 v[48:49], v[48:49], v[32:33]
    v_pk_add_f32 v[48:49], v[48:49], v[36:37]
    ds_read_b128 v[28:31], v19 offset:176
    s_waitcnt lgkmcnt(1)
    v_lshlrev_b32 v32, 16, v24
    v_and_b32 v33, 0xffff0000, v24
    v_lshlrev_b32 v40, 16, v104
    v_and_b32 v41, 0xffff0000, v104
    v_lshlrev_b32 v34, 16, v25
    v_and_b32 v35, 0xffff0000, v25
    v_lshlrev_b32 v42, 16, v105
    v_and_b32 v43, 0xffff0000, v105
    v_lshlrev_b32 v36, 16, v26
    v_and_b32 v37, 0xffff0000, v26
    v_lshlrev_b32 v44, 16, v106
    v_and_b32 v45, 0xffff0000, v106
    v_lshlrev_b32 v38, 16, v27
    v_and_b32 v39, 0xffff0000, v27
    v_lshlrev_b32 v46, 16, v107
    v_and_b32 v47, 0xffff0000, v107
    v_pk_mul_f32 v[32:33], v[32:33], v[40:41]
    v_pk_mul_f32 v[34:35], v[34:35], v[42:43]
    v_pk_mul_f32 v[36:37], v[36:37], v[44:45]
    v_pk_mul_f32 v[38:39], v[38:39], v[46:47]
    v_cvt_pk_bf16_f32 v40, v32, v33
    v_cvt_pk_bf16_f32 v41, v34, v35
    v_cvt_pk_bf16_f32 v42, v36, v37
    v_cvt_pk_bf16_f32 v43, v38, v39
    v_lshlrev_b32 v32, 16, v40
    v_and_b32 v33, 0xffff0000, v40
    v_lshlrev_b32 v34, 16, v41
    v_and_b32 v35, 0xffff0000, v41
    v_lshlrev_b32 v36, 16, v42
    v_and_b32 v37, 0xffff0000, v42
    v_lshlrev_b32 v38, 16, v43
    v_and_b32 v39, 0xffff0000, v43
    v_pk_add_f32 v[32:33], v[32:33], v[34:35]
    v_pk_add_f32 v[36:37], v[36:37], v[38:39]
    v_pk_add_f32 v[48:49], v[48:49], v[32:33]
    v_pk_add_f32 v[48:49], v[48:49], v[36:37]
    ds_read_b128 v[24:27], v19 offset:192
    s_waitcnt lgkmcnt(1)
    v_lshlrev_b32 v32, 16, v28
    v_and_b32 v33, 0xffff0000, v28
    v_lshlrev_b32 v40, 16, v108
    v_and_b32 v41, 0xffff0000, v108
    v_lshlrev_b32 v34, 16, v29
    v_and_b32 v35, 0xffff0000, v29
    v_lshlrev_b32 v42, 16, v109
    v_and_b32 v43, 0xffff0000, v109
    v_lshlrev_b32 v36, 16, v30
    v_and_b32 v37, 0xffff0000, v30
    v_lshlrev_b32 v44, 16, v110
    v_and_b32 v45, 0xffff0000, v110
    v_lshlrev_b32 v38, 16, v31
    v_and_b32 v39, 0xffff0000, v31
    v_lshlrev_b32 v46, 16, v111
    v_and_b32 v47, 0xffff0000, v111
    v_pk_mul_f32 v[32:33], v[32:33], v[40:41]
    v_pk_mul_f32 v[34:35], v[34:35], v[42:43]
    v_pk_mul_f32 v[36:37], v[36:37], v[44:45]
    v_pk_mul_f32 v[38:39], v[38:39], v[46:47]
    v_cvt_pk_bf16_f32 v40, v32, v33
    v_cvt_pk_bf16_f32 v41, v34, v35
    v_cvt_pk_bf16_f32 v42, v36, v37
    v_cvt_pk_bf16_f32 v43, v38, v39
    v_lshlrev_b32 v32, 16, v40
    v_and_b32 v33, 0xffff0000, v40
    v_lshlrev_b32 v34, 16, v41
    v_and_b32 v35, 0xffff0000, v41
    v_lshlrev_b32 v36, 16, v42
    v_and_b32 v37, 0xffff0000, v42
    v_lshlrev_b32 v38, 16, v43
    v_and_b32 v39, 0xffff0000, v43
    v_pk_add_f32 v[32:33], v[32:33], v[34:35]
    v_pk_add_f32 v[36:37], v[36:37], v[38:39]
    v_pk_add_f32 v[48:49], v[48:49], v[32:33]
    v_pk_add_f32 v[48:49], v[48:49], v[36:37]
    ds_read_b128 v[28:31], v19 offset:208
    s_waitcnt lgkmcnt(1)
    v_lshlrev_b32 v32, 16, v24
    v_and_b32 v33, 0xffff0000, v24
    v_lshlrev_b32 v40, 16, v112
    v_and_b32 v41, 0xffff0000, v112
    v_lshlrev_b32 v34, 16, v25
    v_and_b32 v35, 0xffff0000, v25
    v_lshlrev_b32 v42, 16, v113
    v_and_b32 v43, 0xffff0000, v113
    v_lshlrev_b32 v36, 16, v26
    v_and_b32 v37, 0xffff0000, v26
    v_lshlrev_b32 v44, 16, v114
    v_and_b32 v45, 0xffff0000, v114
    v_lshlrev_b32 v38, 16, v27
    v_and_b32 v39, 0xffff0000, v27
    v_lshlrev_b32 v46, 16, v115
    v_and_b32 v47, 0xffff0000, v115
    v_pk_mul_f32 v[32:33], v[32:33], v[40:41]
    v_pk_mul_f32 v[34:35], v[34:35], v[42:43]
    v_pk_mul_f32 v[36:37], v[36:37], v[44:45]
    v_pk_mul_f32 v[38:39], v[38:39], v[46:47]
    v_cvt_pk_bf16_f32 v40, v32, v33
    v_cvt_pk_bf16_f32 v41, v34, v35
    v_cvt_pk_bf16_f32 v42, v36, v37
    v_cvt_pk_bf16_f32 v43, v38, v39
    v_lshlrev_b32 v32, 16, v40
    v_and_b32 v33, 0xffff0000, v40
    v_lshlrev_b32 v34, 16, v41
    v_and_b32 v35, 0xffff0000, v41
    v_lshlrev_b32 v36, 16, v42
    v_and_b32 v37, 0xffff0000, v42
    v_lshlrev_b32 v38, 16, v43
    v_and_b32 v39, 0xffff0000, v43
    v_pk_add_f32 v[32:33], v[32:33], v[34:35]
    v_pk_add_f32 v[36:37], v[36:37], v[38:39]
    v_pk_add_f32 v[48:49], v[48:49], v[32:33]
    v_pk_add_f32 v[48:49], v[48:49], v[36:37]
    s_waitcnt lgkmcnt(0)
    v_lshlrev_b32 v32, 16, v28
    v_and_b32 v33, 0xffff0000, v28
    v_lshlrev_b32 v40, 16, v116
    v_and_b32 v41, 0xffff0000, v116
    v_lshlrev_b32 v34, 16, v29
    v_and_b32 v35, 0xffff0000, v29
    v_lshlrev_b32 v42, 16, v117
    v_and_b32 v43, 0xffff0000, v117
    v_lshlrev_b32 v36, 16, v30
    v_and_b32 v37, 0xffff0000, v30
    v_lshlrev_b32 v44, 16, v118
    v_and_b32 v45, 0xffff0000, v118
    v_lshlrev_b32 v38, 16, v31
    v_and_b32 v39, 0xffff0000, v31
    v_lshlrev_b32 v46, 16, v119
    v_and_b32 v47, 0xffff0000, v119
    v_pk_mul_f32 v[32:33], v[32:33], v[40:41]
    v_pk_mul_f32 v[34:35], v[34:35], v[42:43]
    v_pk_mul_f32 v[36:37], v[36:37], v[44:45]
    v_pk_mul_f32 v[38:39], v[38:39], v[46:47]
    v_cvt_pk_bf16_f32 v40, v32, v33
    v_cvt_pk_bf16_f32 v41, v34, v35
    v_cvt_pk_bf16_f32 v42, v36, v37
    v_cvt_pk_bf16_f32 v43, v38, v39
    v_lshlrev_b32 v32, 16, v40
    v_and_b32 v33, 0xffff0000, v40
    v_lshlrev_b32 v34, 16, v41
    v_and_b32 v35, 0xffff0000, v41
    v_lshlrev_b32 v36, 16, v42
    v_and_b32 v37, 0xffff0000, v42
    v_lshlrev_b32 v38, 16, v43
    v_and_b32 v39, 0xffff0000, v43
    v_pk_add_f32 v[32:33], v[32:33], v[34:35]
    v_pk_add_f32 v[36:37], v[36:37], v[38:39]
    v_pk_add_f32 v[48:49], v[48:49], v[32:33]
    v_pk_add_f32 v[48:49], v[48:49], v[36:37]
    v_add_f32 v48, v48, v49
    s_nop 1
    v_add_f32_dpp v49, v48, v48 quad_perm:[1,0,3,2] row_mask:0xf bank_mask:0xf
    s_nop 1
    v_add_f32_dpp v48, v49, v49 quad_perm:[2,3,0,1] row_mask:0xf bank_mask:0xf
    v_cvt_pk_bf16_f32 v48, v48, v48
    v_and_b32 v48, 0xffff0000, v48
    v_mul_f32 v48, 0xbfb8aa3b, v48
    v_exp_f32 v48, v48
    s_nop 0
    v_add_f32 v48, 1.0, v48
    v_rcp_f32 v48, v48
    s_nop 0
    v_cvt_pk_bf16_f32 v48, v48, v48
    v_and_b32 v48, 0xffff0000, v48
    v_and_b32 v21, 60, v0
    v_lshl_add_u32 v21, v18, 6, v21
    v_and_b32 v18, 2, v18
    v_lshl_add_u32 v21, v18, 20, v21
    s_lshl_b32 s77, s84, 9
    s_lshl_b32 s78, s70, 7
    s_add_u32 s77, s77, s78
    buffer_store_dword v48, v21, s[20:23], s77 offen sc1
    s_waitcnt vmcnt(0)
    s_barrier
    s_cmp_lg_u32 s70, 0
    s_cbranch_scc1 L_P3b
    s_add_u32 s100, s100, 4096
    v_mov_b32 v52, s87
    buffer_store_dwordx4 v[52:55], v13, s[88:91], s100 offen sc1
L_P3b:
    s_nop 0
    s_endpgm
L_end:
    s_endpgm
.section .rodata,"a"
.p2align 6
.amdhsa_kernel gated_mix__ssm_conv_s4__glu_gated_geglu__prompt_kernel
  .amdhsa_next_free_vgpr 256
  .amdhsa_next_free_sgpr 102
  .amdhsa_accum_offset 256
  .amdhsa_group_segment_fixed_size 0
  .amdhsa_kernarg_size 136
  .amdhsa_user_sgpr_count 2
  .amdhsa_user_sgpr_kernarg_segment_ptr 1
  .amdhsa_system_sgpr_workgroup_id_x 1
.end_amdhsa_kernel
```
